```python
import torch

def _softmax(x, axis=-1):
    return torch.softmax(x, dim=axis)

def _gelu(x):
    return torch.nn.functional.gelu(x, approximate='tanh')

def _silu(x):
    return torch.nn.functional.silu(x)

def _sigmoid(x):
    return torch.sigmoid(x)

def _layernorm(x, axis=-1, eps=1e-05):
    m = x.mean(dim=axis, keepdim=True)
    v = x.var(dim=axis, keepdim=True, unbiased=False)
    return (x - m) / torch.sqrt(v + eps)

def _scatter_add(tgt, idx, src, axis=0):
    return tgt.clone().index_add_(axis, idx, src)

def _segment_sum(src, seg, n):
    out = torch.zeros((n,) + src.shape[1:], dtype=src.dtype)
    return out.index_add_(0, seg, src)

def _pad(x, pw):
    flat = tuple((v for pair in reversed(pw) for v in pair))
    return torch.nn.functional.pad(x, flat)
kernel_name = 'standalone__tensor_product_equiv_equiformer__graph'

def setup_inputs():

    _w = lambda a: (lambda t: t.to(torch.bfloat16) if t.is_floating_point() else t)(torch.as_tensor(a))
    N, deg, C, De = (12500, 64, 64, max(4, 1))
    E = N * deg
    src = (lambda lo, hi, *s: torch.randint(lo, hi, s))(0, N, E).to(torch.int64)
    dst = (lambda lo, hi, *s: torch.randint(lo, hi, s))(0, N, E).to(torch.int64)
    rvec = (lambda *s: torch.randn(*s, dtype=torch.bfloat16) * 0.05)(E, 3).to(float)
    rn = (torch.linalg.norm(rvec, dim=-1, keepdim=True) + 1e-06).to(float)
    rhat = (rvec / rn).to(float)
    eps = torch.zeros((3, 3, 3), dtype=float)
    eps[0, 1, 2] = eps[1, 2, 0] = eps[2, 0, 1] = 1.0
    eps[0, 2, 1] = eps[2, 1, 0] = eps[1, 0, 2] = -1.0
    return {'x': _w((lambda *s: torch.randn(*s, dtype=torch.bfloat16) * 0.4)(N, 4 * C).to(float)), 'rhat': _w(rhat), 'e_attr': _w((lambda *s: torch.randn(*s, dtype=torch.bfloat16) * 0.4)(E, De).to(float)), 'src': _w(src), 'dst': _w(dst), 'w_rad': _w((lambda *s: torch.randn(*s, dtype=torch.bfloat16) * 0.4)(De, 5 * C).to(float)), 'w_si0': _w((lambda *s: torch.randn(*s, dtype=torch.bfloat16) * 0.4)(2 * C, C).to(float)), 'w_si1': _w((lambda *s: torch.randn(*s, dtype=torch.bfloat16) * 0.05)(3 * C, C).to(float)), 'cg_eps': _w(eps)}

def reference(x, rhat, e_attr, src, dst, w_rad, w_si0, w_si1, cg_eps):
    N = x.shape[0]
    C = w_si0.shape[1]
    E = rhat.shape[0]
    x0 = x[:, :C].clone()
    x1 = x[:, C:].reshape(N, 3, C)
    R = (e_attr @ w_rad).reshape(E, 5, C)
    f0 = x0[src]
    f1 = x1[src]
    Y1 = rhat
    p00_0 = f0 * R[:, 0, :]
    p11_0 = torch.einsum('ejc,ej->ec', f1, Y1) * R[:, 1, :]
    p01_1 = torch.einsum('ec,ej->ejc', f0, Y1) * R[:, 2, :][:, None, :]
    p10_1 = f1 * R[:, 3, :][:, None, :]
    p11_1 = torch.einsum('ijk,ekc,ej->eic', cg_eps, f1, Y1) * R[:, 4, :][:, None, :]
    m0 = torch.concatenate([p00_0, p11_0], axis=-1) @ w_si0
    m1 = torch.einsum('ejp,pc->ejc', torch.concatenate([p01_1, p10_1, p11_1], axis=-1), w_si1)
    agg0 = _segment_sum(m0, dst, N)
    agg1 = _segment_sum(m1.reshape(E, 3 * C), dst, N).reshape(N, 3, C)
    gate = _sigmoid(agg0)
    out1 = agg1 * gate[:, None, :]
    return torch.concatenate([agg0, out1.reshape(N, 3 * C)], axis=-1)
```

```asm
; @launch grid=(256,1,1) block=(1024,1,1) lds=163840
.amdgcn_target "amdgcn-amd-amdhsa--gfx950"
.text
.p2align 12
.globl standalone__tensor_product_equiv_equiformer__graph_kernel
.p2align 8
.type standalone__tensor_product_equiv_equiformer__graph_kernel,@function
standalone__tensor_product_equiv_equiformer__graph_kernel:
    s_cmp_ge_u32 s2, 256
    s_cbranch_scc1 K2_END
    s_load_dwordx4 s[68:71], s[0:1], 24
    s_load_dwordx4 s[64:67], s[0:1], 8
    s_load_dwordx2 s[12:13], s[0:1], 88
    s_load_dwordx4 s[44:47], s[0:1], 40
    s_load_dwordx2 s[48:49], s[0:1], 56
    s_load_dwordx2 s[8:9], s[0:1], 0
    s_load_dwordx4 s[4:7], s[0:1], 72
    v_readfirstlane_b32 s16, v0
    s_cmp_lt_u32 s2, 250
    s_cselect_b32 s28, 832, 0
    s_cmp_lt_u32 s16, s28
    s_cbranch_scc1 K_BIN
    s_cmp_lt_u32 s2, 250
    s_cbranch_scc1 K_NOCL
    s_mul_i32 s28, s2, 49152
    s_add_u32 s28, s28, 1646592
    v_lshl_add_u32 v1, v0, 4, s28
    v_mov_b64 v[120:121], 0
    v_mov_b64 v[122:123], 0
    v_add_u32 v2, 16384, v1
    v_add_u32 v3, 32768, v1
    s_waitcnt lgkmcnt(0)
    global_store_dwordx4 v1, v[120:123], s[12:13] sc1
    global_store_dwordx4 v2, v[120:123], s[12:13] sc1
    global_store_dwordx4 v3, v[120:123], s[12:13] sc1
K_NOCL:
    s_barrier
    s_branch K_HELP
K_BIN:
    s_mul_i32 s28, s2, 800
    s_cmpk_lt_u32 s16, 768
    s_cselect_b32 s29, 31, 63
    s_cselect_b64 vcc, -1, 0
    v_and_b32 v65, s29, v0
    v_add_lshl_u32 v66, s28, v0, 1
    v_sub_u32 v65, v66, v65
    v_lshlrev_b32 v66, 3, v65
    v_lshlrev_b32 v67, 4, v65
    v_mul_u32_u24 v65, 12, v65
    v_and_b32 v80, 255, v0
    v_lshlrev_b32 v80, 2, v80
    v_mov_b32 v81, 0
    ds_write_b32 v80, v81 offset:45056
    v_mov_b32 v87, 1
    s_movk_i32 s22, -49
    s_waitcnt lgkmcnt(0)
    global_load_dwordx2 v[68:69], v66, s[70:71] nt
    s_cbranch_vccz K_B1
    global_load_dwordx2 v[70:71], v66, s[70:71] offset:256 nt
    s_barrier
    global_load_dwordx2 v[74:75], v66, s[68:69] offset:256 nt
    global_load_dwordx4 v[88:91], v67, s[66:67] offset:512 nt
    global_load_dwordx3 v[96:98], v65, s[64:65] offset:384 nt
    global_load_dwordx2 v[72:73], v66, s[68:69] offset:0 nt
    global_load_dwordx4 v[76:79], v67, s[66:67] offset:0 nt
    global_load_dwordx3 v[84:86], v65, s[64:65] offset:0 nt
    s_waitcnt vmcnt(6)
    v_mul_u32_u24 v102, 21400, v70
    v_mul_u32_u24 v103, 21400, v71
    v_lshrrev_b32 v102, 20, v102
    v_lshrrev_b32 v103, 20, v103
    v_mad_i32_i24 v70, v102, s22, v70
    v_mad_i32_i24 v71, v103, s22, v71
    v_lshlrev_b32 v102, 2, v102
    ds_add_rtn_u32 v106, v102, v87 offset:45056
    v_lshlrev_b32 v103, 2, v103
    ds_add_rtn_u32 v107, v103, v87 offset:45056
    s_branch K_B2
K2_SHORT:
    s_cmp_eq_u64 s[34:35], 0
    v_lshlrev_b32 v96, 4, v88
    s_mov_b64 exec, s[32:33]
    global_load_dwordx4 v[64:67], v96, s[12:13] sc1
    global_load_ubyte v80, v88, s[42:43] sc1
    s_cbranch_scc1 K2_SHORT1
    s_cmp_eq_u64 s[36:37], 0
    v_lshlrev_b32 v96, 4, v89
    s_mov_b64 exec, s[34:35]
    global_load_dwordx4 v[68:71], v96, s[12:13] sc1
    global_load_ubyte v81, v89, s[42:43] sc1
    s_cbranch_scc1 K2_SHORT1
    v_lshlrev_b32 v96, 4, v90
    s_mov_b64 exec, s[36:37]
    global_load_dwordx4 v[72:75], v96, s[12:13] sc1
    global_load_ubyte v82, v90, s[42:43] sc1
K2_SHORT1:
    s_barrier
    s_waitcnt vmcnt(0)
    s_mov_b64 exec, s[32:33]
    v_lshl_add_u32 v80, v80, 2, s28
    ds_add_rtn_u32 v84, v80, v111
    s_mov_b64 exec, s[34:35]
    v_lshl_add_u32 v81, v81, 2, s28
    ds_add_rtn_u32 v85, v81, v111
    s_mov_b64 exec, s[36:37]
    v_lshl_add_u32 v82, v82, 2, s28
    ds_add_rtn_u32 v86, v82, v111
    s_mov_b64 exec, -1
    s_branch K2_Y
K_B1:
    s_barrier
    global_load_dwordx2 v[72:73], v66, s[68:69] offset:0 nt
    global_load_dwordx4 v[76:79], v67, s[66:67] offset:0 nt
    global_load_dwordx3 v[84:86], v65, s[64:65] offset:0 nt
    s_waitcnt vmcnt(3)
K_B2:
    v_mul_u32_u24 v100, 21400, v68
    v_mul_u32_u24 v101, 21400, v69
    v_lshrrev_b32 v100, 20, v100
    v_lshrrev_b32 v101, 20, v101
    v_mad_i32_i24 v68, v100, s22, v68
    v_mad_i32_i24 v69, v101, s22, v69
    v_lshlrev_b32 v100, 2, v100
    ds_add_rtn_u32 v104, v100, v87 offset:45056
    v_lshlrev_b32 v101, 2, v101
    ds_add_rtn_u32 v105, v101, v87 offset:45056
    s_and_b32 s57, s2, 7
    s_lshl_b32 s57, s57, 5
    s_lshr_b32 s28, s2, 3
    s_add_u32 s57, s57, s28
    s_mul_i32 s14, s57, 49
    s_sub_u32 s15, 12500, s14
    s_min_u32 s15, s15, 49
    s_lshl_b32 s30, s15, 1
    s_sub_u32 s54, s15, 1
    s_mov_b32 s10, 6400000
    s_mov_b32 s11, 0x00020000
    s_mov_b32 s26, 0x05040100
    s_mov_b32 s27, 0x07060302
    s_lshr_b32 s16, s16, 6
    s_lshl_b32 s17, s16, 8
    s_lshl2_add_u32 s3, s57, 13934592
    s_mov_b32 s50, 0
    s_add_u32 s42, s12, 13107200
    s_addc_u32 s43, s13, 0
    s_lshl_b32 s55, s16, 10
    s_add_u32 s55, s55, 51200
    v_and_b32 v126, 63, v0
    v_lshlrev_b32 v64, 4, v126
    v_mov_b64 v[120:121], 0
    v_mov_b64 v[122:123], 0
    v_add_u32 v99, s55, v64
    ds_write_b128 v99, v[120:123]
    s_waitcnt lgkmcnt(0)
    s_barrier
    ds_read_b128 v[92:95], v64 offset:45056
    s_waitcnt lgkmcnt(0)
    v_add_u32 v80, v92, v93
    v_add_u32 v81, v80, v94
    v_add_u32 v82, v81, v95
    v_mov_b32 v83, v82
    s_nop 1
    v_add_u32_dpp v83, v83, v83 row_shr:1 row_mask:0xf bank_mask:0xf
    s_nop 1
    v_add_u32_dpp v83, v83, v83 row_shr:2 row_mask:0xf bank_mask:0xf
    s_nop 1
    v_add_u32_dpp v83, v83, v83 row_shr:4 row_mask:0xf bank_mask:0xf
    s_nop 1
    v_add_u32_dpp v83, v83, v83 row_shr:8 row_mask:0xf bank_mask:0xf
    s_nop 1
    v_add_u32_dpp v83, v83, v83 row_bcast:15 row_mask:0xa bank_mask:0xf
    s_nop 1
    v_add_u32_dpp v83, v83, v83 row_bcast:31 row_mask:0xc bank_mask:0xf
    v_sub_u32 v116, v83, v82
    v_add_u32 v117, v116, v92
    v_add_u32 v118, v116, v80
    v_add_u32 v119, v116, v81
    ds_write_b128 v64, v[116:119] offset:46080
    s_mov_b32 s28, 106848
    v_lshlrev_b32 v67, 4, v0
    s_mul_i32 s29, s2, 51200
    s_waitcnt lgkmcnt(0)
    ds_read_b32 v100, v100 offset:46080
    ds_read_b32 v101, v101 offset:46080
    v_add_u32 v66, s28, v67
    v_add_u32 v108, s29, v67
    v_add_u32 v109, 12800, v108
    v_add_u32 v110, 25600, v108
    v_add_u32 v111, 38400, v108
    s_mov_b32 s20, -1
    s_mov_b32 s21, vcc_hi
    s_waitcnt lgkmcnt(0)
    v_add_u32 v100, v100, v104
    ds_write_b8 v100, v68 offset:47104
    v_add_u32 v101, v101, v105
    ds_write_b8 v101, v69 offset:47104
    v_lshl_add_u32 v104, v100, 4, s28
    v_lshl_add_u32 v105, v101, 4, s28
    s_cbranch_vccz K_B3
    ds_read_b32 v102, v102 offset:46080
    ds_read_b32 v103, v103 offset:46080
    s_waitcnt lgkmcnt(0)
    v_add_u32 v102, v102, v106
    ds_write_b8 v102, v70 offset:47104
    v_add_u32 v103, v103, v107
    ds_write_b8 v103, v71 offset:47104
    v_lshl_add_u32 v106, v102, 4, s28
    v_lshl_add_u32 v107, v103, 4, s28
    s_waitcnt vmcnt(3)
    v_alignbit_b32 v92, v98, v97, 16
    v_alignbit_b32 v93, v75, v98, 16
    v_perm_b32 v97, v74, v97, s26
    v_mov_b64 v[94:95], v[88:89]
    ds_write_b128 v107, v[90:93]
    ds_write_b128 v106, v[94:97]
K_B3:
    s_waitcnt vmcnt(0)
    v_alignbit_b32 v80, v86, v85, 16
    v_alignbit_b32 v81, v73, v86, 16
    v_perm_b32 v85, v72, v85, s26
    v_mov_b64 v[82:83], v[76:77]
    ds_write_b128 v105, v[78:81]
    ds_write_b128 v104, v[82:85]
    s_mov_b64 exec, s[20:21]
    s_waitcnt lgkmcnt(0)
    s_barrier
    ds_read_b128 v[72:75], v66 offset:0
    ds_read_b128 v[76:79], v66 offset:12800
    ds_read_b128 v[80:83], v66 offset:25600
    ds_read_b128 v[84:87], v66 offset:38400
    s_waitcnt lgkmcnt(3)
    global_store_dwordx4 v108, v[72:75], s[12:13] sc1
    s_waitcnt lgkmcnt(2)
    global_store_dwordx4 v109, v[76:79], s[12:13] sc1
    s_waitcnt lgkmcnt(1)
    global_store_dwordx4 v110, v[80:83], s[12:13] sc1
    s_waitcnt lgkmcnt(0)
    global_store_dwordx4 v111, v[84:87], s[12:13] sc1
    s_cmp_lt_u32 s16, 4
    s_cbranch_scc0 K_NOBYT
    s_mul_i32 s29, s2, 3200
    v_add_u32 v66, s29, v67
    v_cmp_gt_u32 vcc, 200, v0
    s_mov_b64 exec, vcc
    ds_read_b128 v[88:91], v67 offset:47104
    s_waitcnt lgkmcnt(0)
    global_store_dwordx4 v66, v[88:91], s[42:43] sc1
K_NOBYT:
    s_mov_b64 exec, -1
K_WALK:
    s_cmp_lt_u32 s16, 12
    s_cbranch_scc0 K_WFR
K2_PREP:
    v_lshrrev_b32 v100, 4, v126
    v_lshlrev_b32 v4, 9, v100
    v_lshlrev_b32 v100, 4, v100
    v_add_u32 v100, 106848, v100
    v_and_b32 v101, 3, v126
    v_lshl_add_u32 v0, v101, 1, v100
    v_lshl_add_u32 v1, v101, 6, v100
    v_add_u32 v2, 14, v100
    v_bfe_u32 v101, v126, 2, 2
    v_lshl_add_u32 v1, v101, 1, v1
    v_add_u32 v1, 6, v1
    v_and_b32 v3, 15, v126
    v_lshl_add_u32 v2, v3, 6, v2
    v_lshlrev_b32 v3, 4, v3
    v_add_u32 v4, v4, v3
    v_add_u32 v112, s17, v126
    v_lshl_add_u32 v109, v126, 2, s55
    s_mov_b32 s28, 106496
    v_lshl_add_u32 v110, v126, 2, s28
    v_mov_b32 v111, 1
    v_add_u32 v113, 64, v112
    v_add_u32 v114, 128, v112
    v_add_u32 v115, 192, v112
    s_waitcnt vmcnt(0) lgkmcnt(0)
    s_barrier
    s_cmp_eq_u32 s16, 0
    s_cbranch_scc1 K_TB0
    s_cmp_eq_u32 s16, 1
    s_cbranch_scc1 K_TB1
    s_cmp_eq_u32 s16, 2
    s_cbranch_scc1 K_TB2
    s_cmp_eq_u32 s16, 3
    s_cbranch_scc1 K_TB3
    s_cmp_eq_u32 s16, 4
    s_cbranch_scc1 K_TB4
    s_cmp_eq_u32 s16, 5
    s_cbranch_scc1 K_TB5
K2_WR:
    s_barrier
    ds_read_b32 v108, v110 offset:272
    ds_read2st64_b32 v[88:89], v109 offset0:0 offset1:1
    ds_read2st64_b32 v[90:91], v109 offset0:2 offset1:3
    s_waitcnt lgkmcnt(2)
    v_readlane_b32 s18, v108, 16
    s_sub_u32 s51, s18, s50
    s_min_u32 s51, s51, 3415
    s_cmp_lt_i32 s18, 0
    s_cbranch_scc1 K_RESCUE
    s_cmp_lt_u32 s17, s51
    s_cbranch_scc0 K2_NOWIN
    v_cmp_gt_u32 s[32:33], s51, v112
    v_cmp_gt_u32 s[34:35], s51, v113
    v_cmp_gt_u32 s[36:37], s51, v114
    v_cmp_gt_u32 s[38:39], s51, v115
    s_waitcnt lgkmcnt(0)
    v_max_u32_dpp v108, v108, v108 row_shr:1 row_mask:0xf bank_mask:0xf
    v_max_u32_dpp v88, v88, v88 row_shr:1 row_mask:0xf bank_mask:0xf
    v_max_u32_dpp v89, v89, v89 row_shr:1 row_mask:0xf bank_mask:0xf
    v_max_u32_dpp v90, v90, v90 row_shr:1 row_mask:0xf bank_mask:0xf
    v_max_u32_dpp v91, v91, v91 row_shr:1 row_mask:0xf bank_mask:0xf
    v_max_u32_dpp v108, v108, v108 row_shr:2 row_mask:0xf bank_mask:0xf
    v_max_u32_dpp v88, v88, v88 row_shr:2 row_mask:0xf bank_mask:0xf
    v_max_u32_dpp v89, v89, v89 row_shr:2 row_mask:0xf bank_mask:0xf
    v_max_u32_dpp v90, v90, v90 row_shr:2 row_mask:0xf bank_mask:0xf
    v_max_u32_dpp v91, v91, v91 row_shr:2 row_mask:0xf bank_mask:0xf
    v_max_u32_dpp v108, v108, v108 row_shr:4 row_mask:0xf bank_mask:0xf
    v_max_u32_dpp v88, v88, v88 row_shr:4 row_mask:0xf bank_mask:0xf
    v_max_u32_dpp v89, v89, v89 row_shr:4 row_mask:0xf bank_mask:0xf
    v_max_u32_dpp v90, v90, v90 row_shr:4 row_mask:0xf bank_mask:0xf
    v_max_u32_dpp v91, v91, v91 row_shr:4 row_mask:0xf bank_mask:0xf
    v_max_u32_dpp v108, v108, v108 row_shr:8 row_mask:0xf bank_mask:0xf
    v_max_u32_dpp v88, v88, v88 row_shr:8 row_mask:0xf bank_mask:0xf
    v_max_u32_dpp v89, v89, v89 row_shr:8 row_mask:0xf bank_mask:0xf
    v_max_u32_dpp v90, v90, v90 row_shr:8 row_mask:0xf bank_mask:0xf
    v_max_u32_dpp v91, v91, v91 row_shr:8 row_mask:0xf bank_mask:0xf
    v_max_u32_dpp v88, v88, v88 row_bcast:15 row_mask:0xa bank_mask:0xf
    v_max_u32_dpp v89, v89, v89 row_bcast:15 row_mask:0xa bank_mask:0xf
    v_max_u32_dpp v90, v90, v90 row_bcast:15 row_mask:0xa bank_mask:0xf
    v_max_u32_dpp v91, v91, v91 row_bcast:15 row_mask:0xa bank_mask:0xf
    v_max_u32_dpp v88, v88, v88 row_bcast:31 row_mask:0xc bank_mask:0xf
    v_max_u32_dpp v89, v89, v89 row_bcast:31 row_mask:0xc bank_mask:0xf
    v_max_u32_dpp v90, v90, v90 row_bcast:31 row_mask:0xc bank_mask:0xf
    v_max_u32_dpp v91, v91, v91 row_bcast:31 row_mask:0xc bank_mask:0xf
    v_readlane_b32 s52, v108, s16
    v_readlane_b32 s28, v88, 63
    v_readlane_b32 s29, v89, 63
    v_readlane_b32 s25, v90, 63
    v_max_u32 v88, s52, v88
    s_max_u32 s28, s28, s52
    s_max_u32 s29, s29, s28
    s_max_u32 s25, s25, s29
    v_max_u32 v89, s28, v89
    v_max_u32 v90, s29, v90
    v_max_u32 v91, s25, v91
    s_mov_b32 s28, 106496
    v_add_u32 v88, v88, v112
    v_add_u32 v89, v89, v113
    v_add_u32 v90, v90, v114
    v_add_u32 v91, v91, v115
    s_cmp_eq_u64 s[38:39], 0
    s_barrier
    s_cbranch_scc1 K2_SHORT
    v_lshlrev_b32 v96, 4, v88
    global_load_dwordx4 v[64:67], v96, s[12:13] sc1
    global_load_ubyte v80, v88, s[42:43] sc1
    global_load_ubyte v81, v89, s[42:43] sc1
    global_load_ubyte v82, v90, s[42:43] sc1
    global_load_ubyte v83, v91, s[42:43] sc1
    v_lshlrev_b32 v89, 4, v89
    v_lshlrev_b32 v90, 4, v90
    v_lshlrev_b32 v91, 4, v91
    s_barrier
    global_load_dwordx4 v[68:71], v89, s[12:13] sc1
    global_load_dwordx4 v[72:75], v90, s[12:13] sc1
    s_waitcnt vmcnt(5)
    s_mov_b64 exec, s[32:33]
    v_lshl_add_u32 v80, v80, 2, s28
    ds_add_rtn_u32 v84, v80, v111
    s_waitcnt vmcnt(4)
    s_mov_b64 exec, s[34:35]
    v_lshl_add_u32 v81, v81, 2, s28
    ds_add_rtn_u32 v85, v81, v111
    s_waitcnt vmcnt(3)
    s_mov_b64 exec, s[36:37]
    v_lshl_add_u32 v82, v82, 2, s28
    ds_add_rtn_u32 v86, v82, v111
    s_waitcnt vmcnt(2)
    s_mov_b64 exec, s[38:39]
    v_lshl_add_u32 v83, v83, 2, s28
    ds_add_rtn_u32 v87, v83, v111
    s_mov_b64 exec, -1
    global_load_dwordx4 v[76:79], v91, s[12:13] sc1
K2_Y:
    s_cmp_eq_u64 s[32:33], 0
    s_waitcnt lgkmcnt(0)
    s_barrier
K2_Y1:
    ds_read_b32 v96, v110
    s_mov_b32 s19, 0
    s_mov_b32 s52, 106848
    s_waitcnt lgkmcnt(0)
    v_add_u32 v97, 3, v96
    v_and_b32 v97, -4, v97
    v_mov_b32 v98, v97
    s_nop 1
    v_add_u32_dpp v98, v98, v98 row_shr:1 row_mask:0xf bank_mask:0xf
    s_nop 1
    v_add_u32_dpp v98, v98, v98 row_shr:2 row_mask:0xf bank_mask:0xf
    s_nop 1
    v_add_u32_dpp v98, v98, v98 row_shr:4 row_mask:0xf bank_mask:0xf
    s_nop 1
    v_add_u32_dpp v98, v98, v98 row_shr:8 row_mask:0xf bank_mask:0xf
    s_nop 1
    v_add_u32_dpp v98, v98, v98 row_bcast:15 row_mask:0xa bank_mask:0xf
    s_nop 1
    v_add_u32_dpp v98, v98, v98 row_bcast:31 row_mask:0xc bank_mask:0xf
    v_sub_u32 v99, v98, v96
    s_cbranch_scc1 K2_NOBP
    ds_bpermute_b32 v80, v80, v99
    ds_bpermute_b32 v81, v81, v99
    ds_bpermute_b32 v82, v82, v99
    ds_bpermute_b32 v83, v83, v99
K2_NOBP:
    v_sub_u32 v98, v98, v97
    v_lshl_or_b32 v6, v97, 16, v98
    v_cmp_lt_u32 vcc, 64, v97
    v_lshl_or_b32 v6, v126, 28, v6
    s_nop 0
    v_mbcnt_lo_u32_b32 v100, vcc_lo, 0
    v_mbcnt_hi_u32_b32 v100, vcc_hi, v100
    v_sub_u32 v103, v126, v100
    v_addc_co_u32 v101, s[62:63], 0, v100, vcc
    s_nop 0
    v_add_u32_dpp v102, v103, v100 row_newbcast:0 row_mask:0xf bank_mask:0xf
    v_add_u32_dpp v103, v101, v103 row_newbcast:15 row_mask:0xf bank_mask:0xf
    v_cndmask_b32 v102, v103, v102, vcc
    v_lshlrev_b32 v102, 2, v102
    ds_permute_b32 v6, v102, v6
    s_cbranch_scc1 K2_NOWR
    s_waitcnt lgkmcnt(4)
    v_add_u32 v80, v80, v84
    v_lshl_add_u32 v80, v80, 4, s52
    s_waitcnt lgkmcnt(3)
    v_add_u32 v81, v81, v85
    v_lshl_add_u32 v81, v81, 4, s52
    s_waitcnt lgkmcnt(2)
    v_add_u32 v82, v82, v86
    v_lshl_add_u32 v82, v82, 4, s52
    s_waitcnt lgkmcnt(1)
    v_add_u32 v83, v83, v87
    v_lshl_add_u32 v83, v83, 4, s52
    s_mov_b64 exec, s[32:33]
    s_waitcnt vmcnt(3)
    ds_write_b128 v80, v[64:67]
    s_mov_b64 exec, s[34:35]
    s_waitcnt vmcnt(2)
    ds_write_b128 v81, v[68:71]
    s_mov_b64 exec, s[36:37]
    s_waitcnt vmcnt(1)
    ds_write_b128 v82, v[72:75]
    s_mov_b64 exec, s[38:39]
    s_waitcnt vmcnt(0)
    ds_write_b128 v83, v[76:79]
    s_mov_b64 exec, -1
K2_NOWR:
    s_sub_u32 s29, s16, 13
    s_cbranch_scc1 K2_NOPAD
    v_mov_b32 v123, 0x7fff0000
    v_add_u32 v98, s29, v98
    v_cmp_lt_u32 vcc, v98, v99
    v_lshl_add_u32 v98, v98, 4, s52
    s_mov_b64 exec, vcc
    ds_write_b128 v98, v[120:123]
    s_mov_b64 exec, -1
    s_cmp_eq_u32 s16, 15
    s_cbranch_scc0 K2_NOPAD
    s_lshr_b32 s28, s2, 3
    s_mul_i32 s28, s28, 390
    v_lshrrev_b32 v12, 1, v126
    v_and_b32 v13, 1, v126
    v_add_lshl_u32 v12, v12, s28, 2
    v_add_lshl_u32 v12, v12, v13, 7
    s_bitcmp0_b32 s2, 0
    s_cselect_b32 s28, 1, 0
    v_lshl_add_u32 v12, s28, 8, v12
    s_lshl_b32 s60, s2, 2
    s_lshr_b32 s60, 0x99663300, s60
    s_and_b32 s60, s60, 15
    s_sub_u32 s60, s60, 10
    s_cselect_b32 s28, 12, 0
    s_add_u32 s60, s60, s28
    s_lshl_b32 s60, s60, 14
    buffer_load_dword v20, v12, s[8:11], s60 offen
    s_sub_u32 s60, s60, 163840
    s_cselect_b32 s28, 196608, 0
    s_add_u32 s60, s60, s28
    s_waitcnt lgkmcnt(0)
    s_barrier
    buffer_load_dword v20, v12, s[8:11], s60 offen
    s_branch K2_DONE
K2_NOPAD:
    s_mov_b32 s21, s16
    s_mov_b32 s22, -1
    s_mov_b32 s53, 106756
    s_waitcnt lgkmcnt(0)
    s_barrier
    s_setprio 2
    s_cmp_ge_u32 s16, 12
    s_cbranch_scc1 K2_DONE
    v_mov_b32 v28, 1
    v_mov_b32 v29, 106752
    s_bfm_b64 s[72:73], s15, 0
    s_cmp_eq_u32 s15, 49
    s_cmov_b32 s72, 0xffffffff
    s_cmov_b32 s73, 0x6efff
K2_ITEM:
    v_mov_b32 v8, s53
    s_mov_b64 exec, 1
    ds_add_u32 v8, v28
K2_ITEM2:
    s_mov_b64 exec, -1
    s_cmp_ge_u32 s21, s30
    s_cbranch_scc1 K2_DONE
    s_min_u32 s28, s21, 63
    s_bfm_b64 s[62:63], s28, 0
    s_and_b64 s[62:63], s[62:63], s[72:73]
    s_bcnt1_i32_b64 s29, s[62:63]
    s_sub_u32 s23, s21, s29
    s_bitcmp0_b64 s[72:73], s28
    s_cselect_b32 s28, 1, 0
    s_cselect_b32 s24, 16, 0
    s_cselect_b32 s23, s23, s29
    s_sub_u32 s23, s23, 1
    s_cselect_b32 s23, s54, s23
    s_lshr_b32 s53, s23, 4
    s_lshl2_add_u32 s53, s53, 106720
    s_add_u32 s53, s53, s24
    s_cmp_eq_u32 s28, s22
    v_readlane_b32 s24, v6, s23
    s_cbranch_scc1 K2_SAMEH
    s_mov_b32 s22, s28
    s_bitcmp0_b32 s2, 0
    s_cselect_b32 s31, 1, 0
    s_xor_b32 s31, s22, s31
    s_lshl_b32 s31, s31, 8
    v_mbcnt_lo_u32_b32 v10, -1, 0
    s_mov_b32 s29, 0x42521230
    s_cmov_b32 s29, 0x15415433
    v_mbcnt_hi_u32_b32 v10, -1, v10
    v_and_b32 v11, 0x70, v3
    v_lshrrev_b32 v10, 3, v10
    v_lshlrev_b32 v10, 2, v10
    v_bfe_u32 v5, s29, v10, 4
    v_lshl_add_u32 v5, v5, 7, v11
    v_add_u32 v5, 100352, v5
K2_SAMEH:
    s_lshr_b32 s28, s24, 28
    s_andn2_b32 s23, s23, 15
    s_or_b32 s23, s23, s28
    s_bfe_u32 s25, s24, 0xc0010
    s_cbranch_scc0 K2_EMPTY
    s_and_b32 s29, s25, 4
    s_cselect_b32 s52, 0, -1
    s_add_u32 s25, s25, s29
    s_and_b32 s28, s24, 0xffff
    s_sub_u32 s28, s28, s29
    s_lshl_b32 s28, s28, 4
    s_sub_u32 s20, s28, s19
    s_mov_b32 s19, s28
    s_and_b32 s28, s25, 31
K2_DISP:
    s_cmp_eq_u32 s28, 8
    s_cbranch_scc1 K2_F1
    s_cmp_eq_u32 s28, 16
    s_cbranch_scc1 K2_F2
    s_cmp_eq_u32 s28, 24
    s_cbranch_scc1 K2_F3
    s_branch K2_F4
K2_SB1:
    s_waitcnt vmcnt(0)
    s_branch K2_RB1
K2_SB2:
    s_waitcnt vmcnt(0)
    s_branch K2_RB2
K2_SB3:
    s_waitcnt vmcnt(0)
    s_branch K2_RB3
K2_SB4:
    s_waitcnt vmcnt(0)
    s_branch K2_RB4
K2_EMPTY:
    s_mov_b64 exec, 1
    ds_add_rtn_u32 v7, v29, v28
    s_mov_b64 exec, -1
    s_waitcnt lgkmcnt(0)
    v_readfirstlane_b32 s21, v7
    s_cmp_eq_u32 s50, 0
    s_cbranch_scc0 K2_ITEM
    s_lshl_b32 s28, s23, 11
    s_and_b32 s29, s23, 7
    s_lshl_b32 s29, s29, 5
    s_or_b32 s28, s28, s29
    s_or_b32 s28, s28, s31
    v_xor_b32 v8, s28, v4
    v_mov_b64 v[12:13], 0
    v_mov_b64 v[14:15], 0
    ds_write_b128 v8, v[12:15]
    s_branch K2_ITEM
.p2align 12
K_TB0:
    s_branch K2_WR
K2_F4:
    v_add_u32 v2, s20, v2
    ds_read_u16 v8, v2
    v_add_u32 v0, s20, v0
    v_add_u32 v1, s20, v1
    ds_read_u16_d16_hi v112, v1 offset:0
    ds_read_u16_d16_hi v113, v1 offset:256
    ds_read_u16_d16_hi v114, v1 offset:512
    ds_read_u16_d16_hi v115, v1 offset:768
    ds_read_u16_d16_hi v96, v0 offset:0
    ds_read_u16_d16_hi v97, v0 offset:64
    ds_read_u16_d16_hi v98, v0 offset:128
    ds_read_u16_d16_hi v99, v0 offset:192
    ds_read_u16_d16_hi v100, v0 offset:256
    ds_read_u16_d16_hi v101, v0 offset:320
    v_mov_b64 v[64:65], 0
    v_mov_b64 v[66:67], 0
    s_cmp_eq_u32 s52, 0
    s_waitcnt lgkmcnt(10)
    v_lshlrev_b32 v8, 9, v8
    ds_read_u16_d16_hi v102, v0 offset:384
    ds_read_u16_d16_hi v103, v0 offset:448
    s_cbranch_scc1 K2_SK4
    v_add_u32_dpp v9, v8, v3 row_newbcast:0 row_mask:0xf bank_mask:0xf
    buffer_load_dwordx4 v[64:67], v9, s[8:11], s31 offen
K2_SK4:
    s_cmp_eq_u32 s25, 32
    v_add_u32_dpp v68, v8, v3 row_newbcast:1 row_mask:0xf bank_mask:0xf
    buffer_load_dwordx4 v[68:71], v68, s[8:11], s31 offen
    v_add_u32_dpp v72, v8, v3 row_newbcast:2 row_mask:0xf bank_mask:0xf
    buffer_load_dwordx4 v[72:75], v72, s[8:11], s31 offen
    v_add_u32_dpp v76, v8, v3 row_newbcast:3 row_mask:0xf bank_mask:0xf
    buffer_load_dwordx4 v[76:79], v76, s[8:11], s31 offen
    v_add_u32_dpp v80, v8, v3 row_newbcast:4 row_mask:0xf bank_mask:0xf
    buffer_load_dwordx4 v[80:83], v80, s[8:11], s31 offen
    v_add_u32_dpp v84, v8, v3 row_newbcast:5 row_mask:0xf bank_mask:0xf
    buffer_load_dwordx4 v[84:87], v84, s[8:11], s31 offen
    v_add_u32_dpp v88, v8, v3 row_newbcast:6 row_mask:0xf bank_mask:0xf
    buffer_load_dwordx4 v[88:91], v88, s[8:11], s31 offen
    v_add_u32_dpp v92, v8, v3 row_newbcast:7 row_mask:0xf bank_mask:0xf
    buffer_load_dwordx4 v[92:95], v92, s[8:11], s31 offen
    s_cbranch_scc1 K2_SB4
    v_add_u32_dpp v32, v8, v3 row_newbcast:8 row_mask:0xf bank_mask:0xf
    buffer_load_dwordx4 v[32:35], v32, s[8:11], s31 offen
    ds_read_u16_d16_hi v104, v0 offset:512
    v_add_u32_dpp v36, v8, v3 row_newbcast:9 row_mask:0xf bank_mask:0xf
    buffer_load_dwordx4 v[36:39], v36, s[8:11], s31 offen
    ds_read_u16_d16_hi v105, v0 offset:576
    v_add_u32_dpp v40, v8, v3 row_newbcast:10 row_mask:0xf bank_mask:0xf
    buffer_load_dwordx4 v[40:43], v40, s[8:11], s31 offen
    ds_read_u16_d16_hi v106, v0 offset:640
    v_add_u32_dpp v44, v8, v3 row_newbcast:11 row_mask:0xf bank_mask:0xf
    buffer_load_dwordx4 v[44:47], v44, s[8:11], s31 offen
    ds_read_u16_d16_hi v107, v0 offset:704
    v_add_u32_dpp v48, v8, v3 row_newbcast:12 row_mask:0xf bank_mask:0xf
    buffer_load_dwordx4 v[48:51], v48, s[8:11], s31 offen
    ds_read_u16_d16_hi v108, v0 offset:768
    v_add_u32_dpp v52, v8, v3 row_newbcast:13 row_mask:0xf bank_mask:0xf
    buffer_load_dwordx4 v[52:55], v52, s[8:11], s31 offen
    ds_read_u16_d16_hi v109, v0 offset:832
    v_add_u32_dpp v56, v8, v3 row_newbcast:14 row_mask:0xf bank_mask:0xf
    buffer_load_dwordx4 v[56:59], v56, s[8:11], s31 offen
    ds_read_u16_d16_hi v110, v0 offset:896
    v_add_u32_dpp v60, v8, v3 row_newbcast:15 row_mask:0xf bank_mask:0xf
    buffer_load_dwordx4 v[60:63], v60, s[8:11], s31 offen
    ds_read_u16_d16_hi v111, v0 offset:960
K2_RB4:
    s_movk_i32 s20, 1024
    s_waitcnt lgkmcnt(0)
    v_mul_f32_dpp v96, v112, v96 quad_perm:[0,0,0,0] row_mask:0xf bank_mask:0xe
    v_mul_f32_dpp v97, v112, v97 quad_perm:[1,1,1,1] row_mask:0xf bank_mask:0xe
    v_mul_f32_dpp v98, v112, v98 quad_perm:[2,2,2,2] row_mask:0xf bank_mask:0xe
    v_mul_f32_dpp v99, v112, v99 quad_perm:[3,3,3,3] row_mask:0xf bank_mask:0xe
    v_mul_f32_dpp v100, v113, v100 quad_perm:[0,0,0,0] row_mask:0xf bank_mask:0xe
    v_mul_f32_dpp v101, v113, v101 quad_perm:[1,1,1,1] row_mask:0xf bank_mask:0xe
    v_mul_f32_dpp v102, v113, v102 quad_perm:[2,2,2,2] row_mask:0xf bank_mask:0xe
    v_mul_f32_dpp v103, v113, v103 quad_perm:[3,3,3,3] row_mask:0xf bank_mask:0xe
    v_mul_f32_dpp v104, v114, v104 quad_perm:[0,0,0,0] row_mask:0xf bank_mask:0xe
    v_mul_f32_dpp v105, v114, v105 quad_perm:[1,1,1,1] row_mask:0xf bank_mask:0xe
    v_mul_f32_dpp v106, v114, v106 quad_perm:[2,2,2,2] row_mask:0xf bank_mask:0xe
    v_mul_f32_dpp v107, v114, v107 quad_perm:[3,3,3,3] row_mask:0xf bank_mask:0xe
    v_mul_f32_dpp v108, v115, v108 quad_perm:[0,0,0,0] row_mask:0xf bank_mask:0xe
    v_mul_f32_dpp v109, v115, v109 quad_perm:[1,1,1,1] row_mask:0xf bank_mask:0xe
    v_mul_f32_dpp v110, v115, v110 quad_perm:[2,2,2,2] row_mask:0xf bank_mask:0xe
    v_mul_f32_dpp v111, v115, v111 quad_perm:[3,3,3,3] row_mask:0xf bank_mask:0xe
    v_and_b32 v96, s52, v96
    v_cvt_pk_bf16_f32 v12, v96, v97
    v_cvt_pk_bf16_f32 v13, v98, v99
    v_cvt_pk_bf16_f32 v14, v100, v101
    v_cvt_pk_bf16_f32 v15, v102, v103
    v_cvt_pk_bf16_f32 v24, v104, v105
    v_cvt_pk_bf16_f32 v25, v106, v107
    v_cvt_pk_bf16_f32 v26, v108, v109
    v_cvt_pk_bf16_f32 v27, v110, v111
    s_sub_u32 s25, s25, 64
    s_waitcnt vmcnt(8)
    v_perm_b32 v16, v68, v64, s26
    v_perm_b32 v17, v76, v72, s26
    v_perm_b32 v18, v84, v80, s26
    v_perm_b32 v19, v92, v88, s26
    v_perm_b32 v20, v68, v64, s27
    v_perm_b32 v21, v76, v72, s27
    v_perm_b32 v22, v84, v80, s27
    v_perm_b32 v23, v92, v88, s27
    v_mfma_f32_16x16x32_bf16 v[96:99], v[12:15], v[16:19], 0
    v_perm_b32 v16, v69, v65, s26
    v_perm_b32 v17, v77, v73, s26
    v_perm_b32 v18, v85, v81, s26
    v_perm_b32 v19, v93, v89, s26
    v_mfma_f32_16x16x32_bf16 v[100:103], v[12:15], v[20:23], 0
    v_perm_b32 v20, v69, v65, s27
    v_perm_b32 v21, v77, v73, s27
    v_perm_b32 v22, v85, v81, s27
    v_perm_b32 v23, v93, v89, s27
    v_mfma_f32_16x16x32_bf16 v[104:107], v[12:15], v[16:19], 0
    v_perm_b32 v16, v70, v66, s26
    v_perm_b32 v17, v78, v74, s26
    v_perm_b32 v18, v86, v82, s26
    v_perm_b32 v19, v94, v90, s26
    v_mfma_f32_16x16x32_bf16 v[108:111], v[12:15], v[20:23], 0
    v_perm_b32 v20, v70, v66, s27
    v_perm_b32 v21, v78, v74, s27
    v_perm_b32 v22, v86, v82, s27
    v_perm_b32 v23, v94, v90, s27
    v_mfma_f32_16x16x32_bf16 v[112:115], v[12:15], v[16:19], 0
    v_perm_b32 v16, v71, v67, s26
    v_perm_b32 v17, v79, v75, s26
    v_perm_b32 v18, v87, v83, s26
    v_perm_b32 v19, v95, v91, s26
    v_mfma_f32_16x16x32_bf16 v[116:119], v[12:15], v[20:23], 0
    v_perm_b32 v20, v71, v67, s27
    v_perm_b32 v21, v79, v75, s27
    v_perm_b32 v22, v87, v83, s27
    v_perm_b32 v23, v95, v91, s27
    v_mfma_f32_16x16x32_bf16 v[120:123], v[12:15], v[16:19], 0
    s_nop 0
    v_mfma_f32_16x16x32_bf16 v[124:127], v[12:15], v[20:23], 0
    s_cbranch_scc1 K2_EPI
    s_branch K2_LB
K_TB1:
    s_branch K2_WR
K2_F2:
    v_add_u32 v2, s20, v2
    ds_read_u16 v8, v2
    v_add_u32 v0, s20, v0
    v_add_u32 v1, s20, v1
    ds_read_u16_d16_hi v112, v1 offset:0
    ds_read_u16_d16_hi v113, v1 offset:256
    ds_read_u16_d16_hi v114, v1 offset:512
    ds_read_u16_d16_hi v96, v0 offset:0
    ds_read_u16_d16_hi v97, v0 offset:64
    ds_read_u16_d16_hi v98, v0 offset:128
    ds_read_u16_d16_hi v99, v0 offset:192
    ds_read_u16_d16_hi v100, v0 offset:256
    ds_read_u16_d16_hi v101, v0 offset:320
    v_mov_b64 v[64:65], 0
    v_mov_b64 v[66:67], 0
    s_cmp_eq_u32 s52, 0
    s_waitcnt lgkmcnt(9)
    v_lshlrev_b32 v8, 9, v8
    ds_read_u16_d16_hi v102, v0 offset:384
    ds_read_u16_d16_hi v103, v0 offset:448
    s_cbranch_scc1 K2_SK2
    v_add_u32_dpp v9, v8, v3 row_newbcast:0 row_mask:0xf bank_mask:0xf
    buffer_load_dwordx4 v[64:67], v9, s[8:11], s31 offen
K2_SK2:
    s_cmp_eq_u32 s25, 16
    v_add_u32_dpp v68, v8, v3 row_newbcast:1 row_mask:0xf bank_mask:0xf
    buffer_load_dwordx4 v[68:71], v68, s[8:11], s31 offen
    v_add_u32_dpp v72, v8, v3 row_newbcast:2 row_mask:0xf bank_mask:0xf
    buffer_load_dwordx4 v[72:75], v72, s[8:11], s31 offen
    v_add_u32_dpp v76, v8, v3 row_newbcast:3 row_mask:0xf bank_mask:0xf
    buffer_load_dwordx4 v[76:79], v76, s[8:11], s31 offen
    s_cbranch_scc1 K2_SB2
    v_add_u32_dpp v32, v8, v3 row_newbcast:4 row_mask:0xf bank_mask:0xf
    buffer_load_dwordx4 v[32:35], v32, s[8:11], s31 offen
    ds_read_u16_d16_hi v104, v0 offset:512
    v_add_u32_dpp v36, v8, v3 row_newbcast:5 row_mask:0xf bank_mask:0xf
    buffer_load_dwordx4 v[36:39], v36, s[8:11], s31 offen
    ds_read_u16_d16_hi v105, v0 offset:576
    v_add_u32_dpp v40, v8, v3 row_newbcast:6 row_mask:0xf bank_mask:0xf
    buffer_load_dwordx4 v[40:43], v40, s[8:11], s31 offen
    ds_read_u16_d16_hi v106, v0 offset:640
    v_add_u32_dpp v44, v8, v3 row_newbcast:7 row_mask:0xf bank_mask:0xf
    buffer_load_dwordx4 v[44:47], v44, s[8:11], s31 offen
    ds_read_u16_d16_hi v107, v0 offset:704
    v_add_u32_dpp v48, v8, v3 row_newbcast:8 row_mask:0xf bank_mask:0xf
    buffer_load_dwordx4 v[48:51], v48, s[8:11], s31 offen
    v_add_u32_dpp v52, v8, v3 row_newbcast:9 row_mask:0xf bank_mask:0xf
    buffer_load_dwordx4 v[52:55], v52, s[8:11], s31 offen
    v_add_u32_dpp v56, v8, v3 row_newbcast:10 row_mask:0xf bank_mask:0xf
    buffer_load_dwordx4 v[56:59], v56, s[8:11], s31 offen
    v_add_u32_dpp v60, v8, v3 row_newbcast:11 row_mask:0xf bank_mask:0xf
    buffer_load_dwordx4 v[60:63], v60, s[8:11], s31 offen
K2_RB2:
    s_movk_i32 s20, 768
    s_waitcnt lgkmcnt(0)
    v_mul_f32_dpp v96, v112, v96 quad_perm:[0,0,0,0] row_mask:0xf bank_mask:0xe
    v_mul_f32_dpp v97, v112, v97 quad_perm:[1,1,1,1] row_mask:0xf bank_mask:0xe
    v_mul_f32_dpp v98, v112, v98 quad_perm:[2,2,2,2] row_mask:0xf bank_mask:0xe
    v_mul_f32_dpp v99, v112, v99 quad_perm:[3,3,3,3] row_mask:0xf bank_mask:0xe
    v_mul_f32_dpp v100, v113, v100 quad_perm:[0,0,0,0] row_mask:0xf bank_mask:0xe
    v_mul_f32_dpp v101, v113, v101 quad_perm:[1,1,1,1] row_mask:0xf bank_mask:0xe
    v_mul_f32_dpp v102, v113, v102 quad_perm:[2,2,2,2] row_mask:0xf bank_mask:0xe
    v_mul_f32_dpp v103, v113, v103 quad_perm:[3,3,3,3] row_mask:0xf bank_mask:0xe
    v_mul_f32_dpp v104, v114, v104 quad_perm:[0,0,0,0] row_mask:0xf bank_mask:0xe
    v_mul_f32_dpp v105, v114, v105 quad_perm:[1,1,1,1] row_mask:0xf bank_mask:0xe
    v_mul_f32_dpp v106, v114, v106 quad_perm:[2,2,2,2] row_mask:0xf bank_mask:0xe
    v_mul_f32_dpp v107, v114, v107 quad_perm:[3,3,3,3] row_mask:0xf bank_mask:0xe
    v_and_b32 v96, s52, v96
    v_cvt_pk_bf16_f32 v12, v96, v97
    v_cvt_pk_bf16_f32 v13, v98, v99
    v_cvt_pk_bf16_f32 v24, v100, v101
    v_cvt_pk_bf16_f32 v25, v102, v103
    v_cvt_pk_bf16_f32 v26, v104, v105
    v_cvt_pk_bf16_f32 v27, v106, v107
    s_sub_u32 s25, s25, 48
    s_waitcnt vmcnt(8)
    v_perm_b32 v16, v68, v64, s26
    v_perm_b32 v17, v76, v72, s26
    v_perm_b32 v20, v68, v64, s27
    v_perm_b32 v21, v76, v72, s27
    v_mfma_f32_16x16x16_bf16 v[96:99], v[12:13], v[16:17], 0
    v_perm_b32 v16, v69, v65, s26
    v_perm_b32 v17, v77, v73, s26
    v_mfma_f32_16x16x16_bf16 v[100:103], v[12:13], v[20:21], 0
    v_perm_b32 v20, v69, v65, s27
    v_perm_b32 v21, v77, v73, s27
    v_mfma_f32_16x16x16_bf16 v[104:107], v[12:13], v[16:17], 0
    v_perm_b32 v16, v70, v66, s26
    v_perm_b32 v17, v78, v74, s26
    v_mfma_f32_16x16x16_bf16 v[108:111], v[12:13], v[20:21], 0
    v_perm_b32 v20, v70, v66, s27
    v_perm_b32 v21, v78, v74, s27
    v_mfma_f32_16x16x16_bf16 v[112:115], v[12:13], v[16:17], 0
    v_perm_b32 v16, v71, v67, s26
    v_perm_b32 v17, v79, v75, s26
    v_mfma_f32_16x16x16_bf16 v[116:119], v[12:13], v[20:21], 0
    v_perm_b32 v20, v71, v67, s27
    v_perm_b32 v21, v79, v75, s27
    v_mfma_f32_16x16x16_bf16 v[120:123], v[12:13], v[16:17], 0
    s_nop 0
    v_mfma_f32_16x16x16_bf16 v[124:127], v[12:13], v[20:21], 0
    s_cbranch_scc1 K2_EPI
    s_branch K2_LB
K_TB2:
    s_branch K2_WR
K2_F3:
    v_add_u32 v2, s20, v2
    ds_read_u16 v8, v2
    v_add_u32 v0, s20, v0
    v_add_u32 v1, s20, v1
    ds_read_u16_d16_hi v112, v1 offset:0
    ds_read_u16_d16_hi v113, v1 offset:256
    ds_read_u16_d16_hi v114, v1 offset:512
    ds_read_u16_d16_hi v115, v1 offset:768
    ds_read_u16_d16_hi v96, v0 offset:0
    ds_read_u16_d16_hi v97, v0 offset:64
    ds_read_u16_d16_hi v98, v0 offset:128
    ds_read_u16_d16_hi v99, v0 offset:192
    ds_read_u16_d16_hi v100, v0 offset:256
    ds_read_u16_d16_hi v101, v0 offset:320
    v_mov_b64 v[64:65], 0
    v_mov_b64 v[66:67], 0
    s_cmp_eq_u32 s52, 0
    s_waitcnt lgkmcnt(10)
    v_lshlrev_b32 v8, 9, v8
    ds_read_u16_d16_hi v102, v0 offset:384
    ds_read_u16_d16_hi v103, v0 offset:448
    s_cbranch_scc1 K2_SK3
    v_add_u32_dpp v9, v8, v3 row_newbcast:0 row_mask:0xf bank_mask:0xf
    buffer_load_dwordx4 v[64:67], v9, s[8:11], s31 offen
K2_SK3:
    s_cmp_eq_u32 s25, 24
    v_add_u32_dpp v68, v8, v3 row_newbcast:1 row_mask:0xf bank_mask:0xf
    buffer_load_dwordx4 v[68:71], v68, s[8:11], s31 offen
    v_add_u32_dpp v72, v8, v3 row_newbcast:2 row_mask:0xf bank_mask:0xf
    buffer_load_dwordx4 v[72:75], v72, s[8:11], s31 offen
    v_add_u32_dpp v76, v8, v3 row_newbcast:3 row_mask:0xf bank_mask:0xf
    buffer_load_dwordx4 v[76:79], v76, s[8:11], s31 offen
    v_add_u32_dpp v80, v8, v3 row_newbcast:4 row_mask:0xf bank_mask:0xf
    buffer_load_dwordx4 v[80:83], v80, s[8:11], s31 offen
    v_add_u32_dpp v84, v8, v3 row_newbcast:5 row_mask:0xf bank_mask:0xf
    buffer_load_dwordx4 v[84:87], v84, s[8:11], s31 offen
    s_cbranch_scc1 K2_SB3
    v_add_u32_dpp v32, v8, v3 row_newbcast:6 row_mask:0xf bank_mask:0xf
    buffer_load_dwordx4 v[32:35], v32, s[8:11], s31 offen
    ds_read_u16_d16_hi v104, v0 offset:512
    v_add_u32_dpp v36, v8, v3 row_newbcast:7 row_mask:0xf bank_mask:0xf
    buffer_load_dwordx4 v[36:39], v36, s[8:11], s31 offen
    ds_read_u16_d16_hi v105, v0 offset:576
    v_add_u32_dpp v40, v8, v3 row_newbcast:8 row_mask:0xf bank_mask:0xf
    buffer_load_dwordx4 v[40:43], v40, s[8:11], s31 offen
    ds_read_u16_d16_hi v106, v0 offset:640
    v_add_u32_dpp v44, v8, v3 row_newbcast:9 row_mask:0xf bank_mask:0xf
    buffer_load_dwordx4 v[44:47], v44, s[8:11], s31 offen
    ds_read_u16_d16_hi v107, v0 offset:704
    v_add_u32_dpp v48, v8, v3 row_newbcast:10 row_mask:0xf bank_mask:0xf
    buffer_load_dwordx4 v[48:51], v48, s[8:11], s31 offen
    ds_read_u16_d16_hi v108, v0 offset:768
    v_add_u32_dpp v52, v8, v3 row_newbcast:11 row_mask:0xf bank_mask:0xf
    buffer_load_dwordx4 v[52:55], v52, s[8:11], s31 offen
    ds_read_u16_d16_hi v109, v0 offset:832
    v_add_u32_dpp v56, v8, v3 row_newbcast:12 row_mask:0xf bank_mask:0xf
    buffer_load_dwordx4 v[56:59], v56, s[8:11], s31 offen
    v_add_u32_dpp v60, v8, v3 row_newbcast:13 row_mask:0xf bank_mask:0xf
    buffer_load_dwordx4 v[60:63], v60, s[8:11], s31 offen
K2_RB3:
    s_movk_i32 s20, 896
    s_waitcnt lgkmcnt(0)
    v_mul_f32_dpp v96, v112, v96 quad_perm:[0,0,0,0] row_mask:0xf bank_mask:0xe
    v_mul_f32_dpp v97, v112, v97 quad_perm:[1,1,1,1] row_mask:0xf bank_mask:0xe
    v_mul_f32_dpp v98, v112, v98 quad_perm:[2,2,2,2] row_mask:0xf bank_mask:0xe
    v_mul_f32_dpp v99, v112, v99 quad_perm:[3,3,3,3] row_mask:0xf bank_mask:0xe
    v_mul_f32_dpp v100, v113, v100 quad_perm:[0,0,0,0] row_mask:0xf bank_mask:0xe
    v_mul_f32_dpp v101, v113, v101 quad_perm:[1,1,1,1] row_mask:0xf bank_mask:0xe
    v_mul_f32_dpp v102, v113, v102 quad_perm:[2,2,2,2] row_mask:0xf bank_mask:0xe
    v_mul_f32_dpp v103, v113, v103 quad_perm:[3,3,3,3] row_mask:0xf bank_mask:0xe
    v_mul_f32_dpp v104, v114, v104 quad_perm:[0,0,0,0] row_mask:0xf bank_mask:0xe
    v_mul_f32_dpp v105, v114, v105 quad_perm:[1,1,1,1] row_mask:0xf bank_mask:0xe
    v_mul_f32_dpp v106, v114, v106 quad_perm:[2,2,2,2] row_mask:0xf bank_mask:0xe
    v_mul_f32_dpp v107, v114, v107 quad_perm:[3,3,3,3] row_mask:0xf bank_mask:0xe
    v_mul_f32_dpp v108, v115, v108 quad_perm:[0,0,0,0] row_mask:0xf bank_mask:0xe
    v_mul_f32_dpp v109, v115, v109 quad_perm:[1,1,1,1] row_mask:0xf bank_mask:0xe
    v_and_b32 v96, s52, v96
    v_cvt_pk_bf16_f32 v12, v96, v97
    v_cvt_pk_bf16_f32 v13, v98, v99
    v_cvt_pk_bf16_f32 v14, v100, v101
    v_cvt_pk_bf16_f32 v24, v102, v103
    v_cvt_pk_bf16_f32 v25, v104, v105
    v_cvt_pk_bf16_f32 v26, v106, v107
    v_cvt_pk_bf16_f32 v27, v108, v109
    v_mov_b32 v15, 0
    s_sub_u32 s25, s25, 56
    s_waitcnt vmcnt(8)
    v_mov_b32 v19, 0
    v_mov_b32 v23, 0
    v_perm_b32 v16, v68, v64, s26
    v_perm_b32 v17, v76, v72, s26
    v_perm_b32 v18, v84, v80, s26
    v_perm_b32 v20, v68, v64, s27
    v_perm_b32 v21, v76, v72, s27
    v_perm_b32 v22, v84, v80, s27
    v_mfma_f32_16x16x32_bf16 v[96:99], v[12:15], v[16:19], 0
    v_perm_b32 v16, v69, v65, s26
    v_perm_b32 v17, v77, v73, s26
    v_perm_b32 v18, v85, v81, s26
    v_mfma_f32_16x16x32_bf16 v[100:103], v[12:15], v[20:23], 0
    v_perm_b32 v20, v69, v65, s27
    v_perm_b32 v21, v77, v73, s27
    v_perm_b32 v22, v85, v81, s27
    v_mfma_f32_16x16x32_bf16 v[104:107], v[12:15], v[16:19], 0
    v_perm_b32 v16, v70, v66, s26
    v_perm_b32 v17, v78, v74, s26
    v_perm_b32 v18, v86, v82, s26
    v_mfma_f32_16x16x32_bf16 v[108:111], v[12:15], v[20:23], 0
    v_perm_b32 v20, v70, v66, s27
    v_perm_b32 v21, v78, v74, s27
    v_perm_b32 v22, v86, v82, s27
    v_mfma_f32_16x16x32_bf16 v[112:115], v[12:15], v[16:19], 0
    v_perm_b32 v16, v71, v67, s26
    v_perm_b32 v17, v79, v75, s26
    v_perm_b32 v18, v87, v83, s26
    v_mfma_f32_16x16x32_bf16 v[116:119], v[12:15], v[20:23], 0
    v_perm_b32 v20, v71, v67, s27
    v_perm_b32 v21, v79, v75, s27
    v_perm_b32 v22, v87, v83, s27
    v_mfma_f32_16x16x32_bf16 v[120:123], v[12:15], v[16:19], 0
    s_nop 0
    v_mfma_f32_16x16x32_bf16 v[124:127], v[12:15], v[20:23], 0
    s_cbranch_scc1 K2_EPI
    s_branch K2_LB
K_TB3:
    s_branch K2_WR
K2_LB:
    s_sub_u32 s25, s25, 32
    s_cbranch_scc0 K2_IA
    s_waitcnt vmcnt(0)
K2_CB:
    s_cmp_lt_i32 s25, 0
    v_perm_b32 v16, v36, v32, s26
    v_perm_b32 v17, v44, v40, s26
    v_perm_b32 v18, v52, v48, s26
    v_perm_b32 v19, v60, v56, s26
    v_perm_b32 v20, v36, v32, s27
    v_perm_b32 v21, v44, v40, s27
    v_perm_b32 v22, v52, v48, s27
    v_perm_b32 v23, v60, v56, s27
    v_mfma_f32_16x16x32_bf16 v[96:99], v[24:27], v[16:19], v[96:99]
    v_perm_b32 v16, v37, v33, s26
    v_perm_b32 v17, v45, v41, s26
    v_perm_b32 v18, v53, v49, s26
    v_perm_b32 v19, v61, v57, s26
    v_mfma_f32_16x16x32_bf16 v[100:103], v[24:27], v[20:23], v[100:103]
    v_perm_b32 v20, v37, v33, s27
    v_perm_b32 v21, v45, v41, s27
    v_perm_b32 v22, v53, v49, s27
    v_perm_b32 v23, v61, v57, s27
    v_mfma_f32_16x16x32_bf16 v[104:107], v[24:27], v[16:19], v[104:107]
    v_perm_b32 v16, v38, v34, s26
    v_perm_b32 v17, v46, v42, s26
    v_perm_b32 v18, v54, v50, s26
    v_perm_b32 v19, v62, v58, s26
    v_mfma_f32_16x16x32_bf16 v[108:111], v[24:27], v[20:23], v[108:111]
    v_perm_b32 v20, v38, v34, s27
    v_perm_b32 v21, v46, v42, s27
    v_perm_b32 v22, v54, v50, s27
    v_perm_b32 v23, v62, v58, s27
    v_mfma_f32_16x16x32_bf16 v[112:115], v[24:27], v[16:19], v[112:115]
    v_perm_b32 v16, v39, v35, s26
    v_perm_b32 v17, v47, v43, s26
    v_perm_b32 v18, v55, v51, s26
    v_perm_b32 v19, v63, v59, s26
    v_mfma_f32_16x16x32_bf16 v[116:119], v[24:27], v[20:23], v[116:119]
    v_perm_b32 v20, v39, v35, s27
    v_perm_b32 v21, v47, v43, s27
    v_perm_b32 v22, v55, v51, s27
    v_perm_b32 v23, v63, v59, s27
    v_mfma_f32_16x16x32_bf16 v[120:123], v[24:27], v[16:19], v[120:123]
    s_nop 0
    v_mfma_f32_16x16x32_bf16 v[124:127], v[24:27], v[20:23], v[124:127]
    s_cbranch_scc1 K2_EPI
    s_sub_u32 s25, s25, 32
    s_cbranch_scc0 K2_IB
    s_waitcnt vmcnt(0)
K2_CA:
    s_cmp_lt_i32 s25, 0
    v_perm_b32 v16, v68, v64, s26
    v_perm_b32 v17, v76, v72, s26
    v_perm_b32 v18, v84, v80, s26
    v_perm_b32 v19, v92, v88, s26
    v_perm_b32 v20, v68, v64, s27
    v_perm_b32 v21, v76, v72, s27
    v_perm_b32 v22, v84, v80, s27
    v_perm_b32 v23, v92, v88, s27
    v_mfma_f32_16x16x32_bf16 v[96:99], v[12:15], v[16:19], v[96:99]
    v_perm_b32 v16, v69, v65, s26
    v_perm_b32 v17, v77, v73, s26
    v_perm_b32 v18, v85, v81, s26
    v_perm_b32 v19, v93, v89, s26
    v_mfma_f32_16x16x32_bf16 v[100:103], v[12:15], v[20:23], v[100:103]
    v_perm_b32 v20, v69, v65, s27
    v_perm_b32 v21, v77, v73, s27
    v_perm_b32 v22, v85, v81, s27
    v_perm_b32 v23, v93, v89, s27
    v_mfma_f32_16x16x32_bf16 v[104:107], v[12:15], v[16:19], v[104:107]
    v_perm_b32 v16, v70, v66, s26
    v_perm_b32 v17, v78, v74, s26
    v_perm_b32 v18, v86, v82, s26
    v_perm_b32 v19, v94, v90, s26
    v_mfma_f32_16x16x32_bf16 v[108:111], v[12:15], v[20:23], v[108:111]
    v_perm_b32 v20, v70, v66, s27
    v_perm_b32 v21, v78, v74, s27
    v_perm_b32 v22, v86, v82, s27
    v_perm_b32 v23, v94, v90, s27
    v_mfma_f32_16x16x32_bf16 v[112:115], v[12:15], v[16:19], v[112:115]
    v_perm_b32 v16, v71, v67, s26
    v_perm_b32 v17, v79, v75, s26
    v_perm_b32 v18, v87, v83, s26
    v_perm_b32 v19, v95, v91, s26
    v_mfma_f32_16x16x32_bf16 v[116:119], v[12:15], v[20:23], v[116:119]
    v_perm_b32 v20, v71, v67, s27
    v_perm_b32 v21, v79, v75, s27
    v_perm_b32 v22, v87, v83, s27
    v_perm_b32 v23, v95, v91, s27
    v_mfma_f32_16x16x32_bf16 v[120:123], v[12:15], v[16:19], v[120:123]
    s_nop 0
    v_mfma_f32_16x16x32_bf16 v[124:127], v[12:15], v[20:23], v[124:127]
    s_cbranch_scc0 K2_LB
K2_EPI:
    s_mov_b64 exec, 1
    ds_add_rtn_u32 v7, v29, v28
    s_mov_b64 exec, -1
    ds_read_b128 v[64:67], v5 offset:0
    ds_read_b128 v[68:71], v5 offset:768
    ds_read_b128 v[72:75], v5 offset:1536
    ds_read_b128 v[76:79], v5 offset:2304
    ds_read_b128 v[80:83], v5 offset:3072
    ds_read_b128 v[84:87], v5 offset:3840
    ds_read_b128 v[88:91], v5 offset:4608
    ds_read_b128 v[92:95], v5 offset:5376
    s_lshl_b32 s28, s23, 11
    s_and_b32 s29, s23, 7
    s_lshl_b32 s29, s29, 5
    s_or_b32 s28, s28, s29
    s_or_b32 s28, s28, s31
    v_xor_b32 v8, s28, v4
    s_cmp_eq_u32 s50, 0
    s_waitcnt lgkmcnt(6)
    v_mul_f32 v16, v64, v96
    v_mul_f32 v17, v68, v100
    v_fmac_f32 v16, v65, v97
    v_fmac_f32 v17, v69, v101
    v_fmac_f32 v16, v66, v98
    v_fmac_f32 v17, v70, v102
    v_fmac_f32 v16, v67, v99
    v_fmac_f32 v17, v71, v103
    s_waitcnt lgkmcnt(4)
    v_readfirstlane_b32 s21, v7
    v_mul_f32 v18, v72, v104
    v_mul_f32 v19, v76, v108
    v_fmac_f32 v18, v73, v105
    v_fmac_f32 v19, v77, v109
    v_fmac_f32 v18, v74, v106
    v_fmac_f32 v19, v78, v110
    v_fmac_f32 v18, v75, v107
    v_fmac_f32 v19, v79, v111
    s_waitcnt lgkmcnt(2)
    v_mul_f32 v20, v80, v112
    v_mul_f32 v21, v84, v116
    v_fmac_f32 v20, v81, v113
    v_fmac_f32 v21, v85, v117
    v_fmac_f32 v20, v82, v114
    v_fmac_f32 v21, v86, v118
    v_fmac_f32 v20, v83, v115
    v_fmac_f32 v21, v87, v119
    s_waitcnt lgkmcnt(0)
    v_mul_f32 v22, v88, v120
    v_mul_f32 v23, v92, v124
    v_fmac_f32 v22, v89, v121
    v_fmac_f32 v23, v93, v125
    v_fmac_f32 v22, v90, v122
    v_fmac_f32 v23, v94, v126
    v_fmac_f32 v22, v91, v123
    v_fmac_f32 v23, v95, v127
    s_cbranch_scc0 K2_ACC
K2_NOACC:
    v_mov_b32 v9, s53
    v_cvt_pk_bf16_f32 v12, v16, v17
    v_cvt_pk_bf16_f32 v13, v18, v19
    v_cvt_pk_bf16_f32 v14, v20, v21
    v_cvt_pk_bf16_f32 v15, v22, v23
    ds_write_b128 v8, v[12:15]
    s_mov_b64 exec, 1
    ds_add_u32 v9, v28
    s_branch K2_ITEM2
K_TB4:
    s_branch K2_WR
K2_IA:
    s_add_u32 s19, s19, s20
    v_add_u32 v2, s20, v2
    ds_read_u16 v8, v2
    v_add_u32 v0, s20, v0
    v_add_u32 v1, s20, v1
    ds_read_u16_d16_hi v16, v0 offset:0
    ds_read_u16_d16_hi v17, v0 offset:64
    ds_read_u16_d16_hi v18, v0 offset:128
    ds_read_u16_d16_hi v19, v0 offset:192
    ds_read_u16_d16_hi v20, v0 offset:256
    ds_read_u16_d16_hi v21, v0 offset:320
    ds_read_u16_d16_hi v22, v0 offset:384
    ds_read_u16_d16_hi v23, v0 offset:448
    s_movk_i32 s20, 512
    s_waitcnt lgkmcnt(8)
    v_lshlrev_b32 v8, 9, v8
    ds_read_u16_d16_hi v10, v1 offset:0
    ds_read_u16_d16_hi v11, v1 offset:256
    v_add_u32_dpp v64, v8, v3 row_newbcast:0 row_mask:0xf bank_mask:0xf
    buffer_load_dwordx4 v[64:67], v64, s[8:11], s31 offen
    v_add_u32_dpp v68, v8, v3 row_newbcast:1 row_mask:0xf bank_mask:0xf
    buffer_load_dwordx4 v[68:71], v68, s[8:11], s31 offen
    v_add_u32_dpp v72, v8, v3 row_newbcast:2 row_mask:0xf bank_mask:0xf
    buffer_load_dwordx4 v[72:75], v72, s[8:11], s31 offen
    v_add_u32_dpp v76, v8, v3 row_newbcast:3 row_mask:0xf bank_mask:0xf
    buffer_load_dwordx4 v[76:79], v76, s[8:11], s31 offen
    v_add_u32_dpp v80, v8, v3 row_newbcast:4 row_mask:0xf bank_mask:0xf
    buffer_load_dwordx4 v[80:83], v80, s[8:11], s31 offen
    v_add_u32_dpp v84, v8, v3 row_newbcast:5 row_mask:0xf bank_mask:0xf
    buffer_load_dwordx4 v[84:87], v84, s[8:11], s31 offen
    v_add_u32_dpp v88, v8, v3 row_newbcast:6 row_mask:0xf bank_mask:0xf
    buffer_load_dwordx4 v[88:91], v88, s[8:11], s31 offen
    v_add_u32_dpp v92, v8, v3 row_newbcast:7 row_mask:0xf bank_mask:0xf
    buffer_load_dwordx4 v[92:95], v92, s[8:11], s31 offen
    s_waitcnt lgkmcnt(0)
    v_mul_f32_dpp v16, v10, v16 quad_perm:[0,0,0,0] row_mask:0xf bank_mask:0xe
    v_mul_f32_dpp v17, v10, v17 quad_perm:[1,1,1,1] row_mask:0xf bank_mask:0xe
    v_mul_f32_dpp v18, v10, v18 quad_perm:[2,2,2,2] row_mask:0xf bank_mask:0xe
    v_mul_f32_dpp v19, v10, v19 quad_perm:[3,3,3,3] row_mask:0xf bank_mask:0xe
    v_mul_f32_dpp v20, v11, v20 quad_perm:[0,0,0,0] row_mask:0xf bank_mask:0xe
    v_mul_f32_dpp v21, v11, v21 quad_perm:[1,1,1,1] row_mask:0xf bank_mask:0xe
    v_mul_f32_dpp v22, v11, v22 quad_perm:[2,2,2,2] row_mask:0xf bank_mask:0xe
    v_mul_f32_dpp v23, v11, v23 quad_perm:[3,3,3,3] row_mask:0xf bank_mask:0xe
    v_cvt_pk_bf16_f32 v12, v16, v17
    v_cvt_pk_bf16_f32 v13, v18, v19
    v_cvt_pk_bf16_f32 v14, v20, v21
    v_cvt_pk_bf16_f32 v15, v22, v23
    s_waitcnt vmcnt(8)
    s_branch K2_CB
.p2align 12
K_TB5:
    s_branch K2_WR
K2_IB:
    s_add_u32 s19, s19, s20
    v_add_u32 v2, s20, v2
    ds_read_u16 v8, v2
    v_add_u32 v0, s20, v0
    v_add_u32 v1, s20, v1
    ds_read_u16_d16_hi v16, v0 offset:0
    ds_read_u16_d16_hi v17, v0 offset:64
    ds_read_u16_d16_hi v18, v0 offset:128
    ds_read_u16_d16_hi v19, v0 offset:192
    ds_read_u16_d16_hi v20, v0 offset:256
    ds_read_u16_d16_hi v21, v0 offset:320
    ds_read_u16_d16_hi v22, v0 offset:384
    ds_read_u16_d16_hi v23, v0 offset:448
    s_movk_i32 s20, 512
    s_waitcnt lgkmcnt(8)
    v_lshlrev_b32 v8, 9, v8
    ds_read_u16_d16_hi v10, v1 offset:0
    ds_read_u16_d16_hi v11, v1 offset:256
    v_add_u32_dpp v32, v8, v3 row_newbcast:0 row_mask:0xf bank_mask:0xf
    buffer_load_dwordx4 v[32:35], v32, s[8:11], s31 offen
    v_add_u32_dpp v36, v8, v3 row_newbcast:1 row_mask:0xf bank_mask:0xf
    buffer_load_dwordx4 v[36:39], v36, s[8:11], s31 offen
    v_add_u32_dpp v40, v8, v3 row_newbcast:2 row_mask:0xf bank_mask:0xf
    buffer_load_dwordx4 v[40:43], v40, s[8:11], s31 offen
    v_add_u32_dpp v44, v8, v3 row_newbcast:3 row_mask:0xf bank_mask:0xf
    buffer_load_dwordx4 v[44:47], v44, s[8:11], s31 offen
    v_add_u32_dpp v48, v8, v3 row_newbcast:4 row_mask:0xf bank_mask:0xf
    buffer_load_dwordx4 v[48:51], v48, s[8:11], s31 offen
    v_add_u32_dpp v52, v8, v3 row_newbcast:5 row_mask:0xf bank_mask:0xf
    buffer_load_dwordx4 v[52:55], v52, s[8:11], s31 offen
    v_add_u32_dpp v56, v8, v3 row_newbcast:6 row_mask:0xf bank_mask:0xf
    buffer_load_dwordx4 v[56:59], v56, s[8:11], s31 offen
    v_add_u32_dpp v60, v8, v3 row_newbcast:7 row_mask:0xf bank_mask:0xf
    buffer_load_dwordx4 v[60:63], v60, s[8:11], s31 offen
    s_waitcnt lgkmcnt(0)
    v_mul_f32_dpp v16, v10, v16 quad_perm:[0,0,0,0] row_mask:0xf bank_mask:0xe
    v_mul_f32_dpp v17, v10, v17 quad_perm:[1,1,1,1] row_mask:0xf bank_mask:0xe
    v_mul_f32_dpp v18, v10, v18 quad_perm:[2,2,2,2] row_mask:0xf bank_mask:0xe
    v_mul_f32_dpp v19, v10, v19 quad_perm:[3,3,3,3] row_mask:0xf bank_mask:0xe
    v_mul_f32_dpp v20, v11, v20 quad_perm:[0,0,0,0] row_mask:0xf bank_mask:0xe
    v_mul_f32_dpp v21, v11, v21 quad_perm:[1,1,1,1] row_mask:0xf bank_mask:0xe
    v_mul_f32_dpp v22, v11, v22 quad_perm:[2,2,2,2] row_mask:0xf bank_mask:0xe
    v_mul_f32_dpp v23, v11, v23 quad_perm:[3,3,3,3] row_mask:0xf bank_mask:0xe
    v_cvt_pk_bf16_f32 v24, v16, v17
    v_cvt_pk_bf16_f32 v25, v18, v19
    v_cvt_pk_bf16_f32 v26, v20, v21
    v_cvt_pk_bf16_f32 v27, v22, v23
    s_waitcnt vmcnt(8)
    s_branch K2_CA
K2_F1:
    v_add_u32 v2, s20, v2
    ds_read_u16 v8, v2
    v_add_u32 v0, s20, v0
    v_add_u32 v1, s20, v1
    ds_read_u16_d16_hi v112, v1 offset:0
    ds_read_u16_d16_hi v113, v1 offset:256
    ds_read_u16_d16_hi v114, v1 offset:512
    ds_read_u16_d16_hi v96, v0 offset:0
    ds_read_u16_d16_hi v97, v0 offset:64
    ds_read_u16_d16_hi v98, v0 offset:128
    ds_read_u16_d16_hi v99, v0 offset:192
    ds_read_u16_d16_hi v100, v0 offset:256
    ds_read_u16_d16_hi v101, v0 offset:320
    v_mov_b64 v[64:65], 0
    v_mov_b64 v[66:67], 0
    s_cmp_eq_u32 s52, 0
    s_waitcnt lgkmcnt(9)
    v_lshlrev_b32 v8, 9, v8
    ds_read_u16_d16_hi v102, v0 offset:384
    ds_read_u16_d16_hi v103, v0 offset:448
    s_cbranch_scc1 K2_SK1
    v_add_u32_dpp v9, v8, v3 row_newbcast:0 row_mask:0xf bank_mask:0xf
    buffer_load_dwordx4 v[64:67], v9, s[8:11], s31 offen
K2_SK1:
    s_cmp_eq_u32 s25, 8
    v_add_u32_dpp v68, v8, v3 row_newbcast:1 row_mask:0xf bank_mask:0xf
    buffer_load_dwordx4 v[68:71], v68, s[8:11], s31 offen
    s_cbranch_scc1 K2_SB1
    v_add_u32_dpp v32, v8, v3 row_newbcast:2 row_mask:0xf bank_mask:0xf
    buffer_load_dwordx4 v[32:35], v32, s[8:11], s31 offen
    ds_read_u16_d16_hi v104, v0 offset:512
    v_add_u32_dpp v36, v8, v3 row_newbcast:3 row_mask:0xf bank_mask:0xf
    buffer_load_dwordx4 v[36:39], v36, s[8:11], s31 offen
    ds_read_u16_d16_hi v105, v0 offset:576
    v_add_u32_dpp v40, v8, v3 row_newbcast:4 row_mask:0xf bank_mask:0xf
    buffer_load_dwordx4 v[40:43], v40, s[8:11], s31 offen
    v_add_u32_dpp v44, v8, v3 row_newbcast:5 row_mask:0xf bank_mask:0xf
    buffer_load_dwordx4 v[44:47], v44, s[8:11], s31 offen
    v_add_u32_dpp v48, v8, v3 row_newbcast:6 row_mask:0xf bank_mask:0xf
    buffer_load_dwordx4 v[48:51], v48, s[8:11], s31 offen
    v_add_u32_dpp v52, v8, v3 row_newbcast:7 row_mask:0xf bank_mask:0xf
    buffer_load_dwordx4 v[52:55], v52, s[8:11], s31 offen
    v_add_u32_dpp v56, v8, v3 row_newbcast:8 row_mask:0xf bank_mask:0xf
    buffer_load_dwordx4 v[56:59], v56, s[8:11], s31 offen
    v_add_u32_dpp v60, v8, v3 row_newbcast:9 row_mask:0xf bank_mask:0xf
    buffer_load_dwordx4 v[60:63], v60, s[8:11], s31 offen
K2_RB1:
    s_movk_i32 s20, 640
    s_waitcnt lgkmcnt(0)
    v_mul_f32_dpp v96, v112, v96 quad_perm:[0,0,0,0] row_mask:0xf bank_mask:0xe
    v_mul_f32_dpp v97, v112, v97 quad_perm:[1,1,1,1] row_mask:0xf bank_mask:0xe
    v_mul_f32_dpp v98, v112, v98 quad_perm:[2,2,2,2] row_mask:0xf bank_mask:0xe
    v_mul_f32_dpp v99, v112, v99 quad_perm:[3,3,3,3] row_mask:0xf bank_mask:0xe
    v_mul_f32_dpp v100, v113, v100 quad_perm:[0,0,0,0] row_mask:0xf bank_mask:0xe
    v_mul_f32_dpp v101, v113, v101 quad_perm:[1,1,1,1] row_mask:0xf bank_mask:0xe
    v_mul_f32_dpp v102, v113, v102 quad_perm:[2,2,2,2] row_mask:0xf bank_mask:0xe
    v_mul_f32_dpp v103, v113, v103 quad_perm:[3,3,3,3] row_mask:0xf bank_mask:0xe
    v_mul_f32_dpp v104, v114, v104 quad_perm:[0,0,0,0] row_mask:0xf bank_mask:0xe
    v_mul_f32_dpp v105, v114, v105 quad_perm:[1,1,1,1] row_mask:0xf bank_mask:0xe
    v_and_b32 v96, s52, v96
    v_cvt_pk_bf16_f32 v12, v96, v97
    v_cvt_pk_bf16_f32 v24, v98, v99
    v_cvt_pk_bf16_f32 v25, v100, v101
    v_cvt_pk_bf16_f32 v26, v102, v103
    v_cvt_pk_bf16_f32 v27, v104, v105
    v_mov_b32 v13, 0
    s_sub_u32 s25, s25, 40
    s_waitcnt vmcnt(8)
    v_mov_b32 v17, 0
    v_mov_b32 v21, 0
    v_perm_b32 v16, v68, v64, s26
    v_perm_b32 v20, v68, v64, s27
    s_nop 0
    v_mfma_f32_16x16x16_bf16 v[96:99], v[12:13], v[16:17], 0
    v_perm_b32 v16, v69, v65, s26
    v_mfma_f32_16x16x16_bf16 v[100:103], v[12:13], v[20:21], 0
    v_perm_b32 v20, v69, v65, s27
    v_mfma_f32_16x16x16_bf16 v[104:107], v[12:13], v[16:17], 0
    v_perm_b32 v16, v70, v66, s26
    v_mfma_f32_16x16x16_bf16 v[108:111], v[12:13], v[20:21], 0
    v_perm_b32 v20, v70, v66, s27
    v_mfma_f32_16x16x16_bf16 v[112:115], v[12:13], v[16:17], 0
    v_perm_b32 v16, v71, v67, s26
    v_mfma_f32_16x16x16_bf16 v[116:119], v[12:13], v[20:21], 0
    v_perm_b32 v20, v71, v67, s27
    v_mfma_f32_16x16x16_bf16 v[120:123], v[12:13], v[16:17], 0
    s_nop 0
    v_mfma_f32_16x16x16_bf16 v[124:127], v[12:13], v[20:21], 0
    s_cbranch_scc1 K2_EPI
    s_branch K2_LB
K2_DONE:
    s_setprio 3
    s_add_u32 s50, s50, 3415
    s_cmp_lt_u32 s50, s18
    v_mbcnt_lo_u32_b32 v0, -1, 0
    v_mbcnt_hi_u32_b32 v0, -1, v0
    s_waitcnt vmcnt(0) lgkmcnt(0)
    s_cbranch_scc0 K2_LAST
    v_mov_b32 v126, v0
    s_barrier
    s_branch K2_ROUND
K2_LAST:
    s_sub_u32 s19, s16, 12
    s_cbranch_scc1 K2_OUT
    v_mov_b32 v2, 1
    v_and_b32 v1, 15, v0
    v_lshrrev_b32 v3, 4, v0
    v_and_b32 v5, 7, v0
    v_lshlrev_b32 v4, 1, v5
    v_xor_b32 v4, v4, v3
    v_lshlrev_b32 v4, 4, v4
    v_lshl_add_u32 v8, v1, 11, v4
    s_lshl_b32 s29, s19, 5
    v_lshl_add_u32 v5, v5, 4, s29
    v_lshl_add_u32 v5, v3, 3, v5
    v_lshl_add_u32 v9, v1, 11, v5
    v_lshrrev_b32 v3, 5, v0
    v_lshl_add_u32 v3, s19, 2, v3
    v_and_b32 v4, 7, v3
    v_and_b32 v5, 7, v0
    v_add_lshl_u32 v4, v4, v5, 4
    v_bfe_u32 v5, v0, 3, 2
    v_lshl_add_u32 v4, v5, 9, v4
    v_lshl_add_u32 v10, v3, 11, v4
    s_bitcmp0_b32 s2, 0
    s_cselect_b32 s28, 1, 0
    v_lshl_add_u32 v9, s28, 8, v9
    v_lshl_add_u32 v10, s28, 8, v10
    s_lshl2_add_u32 s28, s19, s14
    s_lshl_b32 s28, s28, 9
    v_lshl_add_u32 v0, v0, 4, s28
    s_mov_b32 s20, 0x42103
K2_TASK:
    s_and_b32 s24, s20, 7
    s_lshl_b32 s23, s24, 4
    s_sub_u32 s25, s15, s23
    s_cmp_gt_i32 s25, 0
    s_cbranch_scc0 K2_NEXT
    s_min_u32 s25, s25, 16
    s_lshl2_add_u32 s28, s24, 106720
    v_mov_b32 v124, s28
    s_cmp_eq_u32 s24, 3
    s_cbranch_scc1 K2_G3
    s_lshl_b32 s28, s24, 15
    v_add_u32 v4, s28, v8
    v_xor_b32 v5, 64, v4
    v_xor_b32 v6, 128, v4
    v_xor_b32 v7, 192, v4
    v_add_u32 v11, s28, v9
    v_add_u32 v12, s28, v10
    s_lshl_b32 s28, s24, 13
    v_add_u32 v13, s28, v0
    v_cmp_gt_u32 s[34:35], s25, v3
    s_sub_u32 s28, s25, 2
    v_cmp_gt_i32 s[36:37], s28, v3
    s_add_u32 s29, s25, 4
    s_bitcmp0_b32 s2, 0
    s_mov_b64 exec, 1
    s_setprio 0
K2_WAITA:
    ds_read_b32 v125, v124 offset:0
    s_waitcnt lgkmcnt(0)
    v_cmp_gt_u32 vcc, s25, v125
    s_cbranch_vccnz K2_WAITA
    s_setprio 3
    s_mov_b64 exec, -1
    s_cbranch_scc1 K2_FLIP
    ds_read_b128 v[64:67], v4 offset:0
    ds_read_b128 v[68:71], v5 offset:0
    ds_read_b128 v[72:75], v4 offset:512
    ds_read_b128 v[76:79], v5 offset:512
    ds_read_b128 v[80:83], v4 offset:1024
    ds_read_b128 v[84:87], v5 offset:1024
    ds_read_b128 v[88:91], v4 offset:1536
    ds_read_b128 v[92:95], v5 offset:1536
    ds_read_b128 v[16:19], v6 offset:512
    ds_read_b128 v[20:23], v7 offset:512
    s_waitcnt lgkmcnt(9)
    v_mfma_f32_16x16x32_bf16 v[96:99], v[24:27], v[64:67], 0
    ds_read_b128 v[64:67], v6 offset:0
    s_waitcnt lgkmcnt(9)
    v_mfma_f32_16x16x32_bf16 v[96:99], v[28:31], v[68:71], v[96:99]
    ds_read_b128 v[68:71], v7 offset:0
    s_waitcnt lgkmcnt(9)
    v_mfma_f32_16x16x32_bf16 v[100:103], v[40:43], v[72:75], 0
    ds_read_b128 v[72:75], v6 offset:1536
    s_waitcnt lgkmcnt(9)
    v_mfma_f32_16x16x32_bf16 v[100:103], v[44:47], v[76:79], v[100:103]
    ds_read_b128 v[76:79], v7 offset:1536
    s_waitcnt lgkmcnt(9)
    v_mfma_f32_16x16x32_bf16 v[104:107], v[40:43], v[80:83], 0
    ds_read_b128 v[80:83], v6 offset:1024
    s_waitcnt lgkmcnt(9)
    v_mfma_f32_16x16x32_bf16 v[104:107], v[44:47], v[84:87], v[104:107]
    ds_read_b128 v[84:87], v7 offset:1024
    s_mov_b64 exec, 1
    ds_add_u32 v124, v2 offset:0
    s_mov_b64 exec, -1
    s_waitcnt lgkmcnt(10)
    v_mfma_f32_16x16x32_bf16 v[108:111], v[40:43], v[88:91], 0
    s_waitcnt lgkmcnt(9)
    v_mfma_f32_16x16x32_bf16 v[108:111], v[44:47], v[92:95], v[108:111]
    s_waitcnt lgkmcnt(8)
    v_mfma_f32_16x16x32_bf16 v[96:99], v[32:35], v[16:19], v[96:99]
    s_waitcnt lgkmcnt(7)
    v_mfma_f32_16x16x32_bf16 v[96:99], v[36:39], v[20:23], v[96:99]
    s_waitcnt lgkmcnt(6)
    v_mfma_f32_16x16x32_bf16 v[100:103], v[48:51], v[64:67], v[100:103]
    s_waitcnt lgkmcnt(5)
    v_mfma_f32_16x16x32_bf16 v[100:103], v[52:55], v[68:71], v[100:103]
    s_waitcnt lgkmcnt(4)
    v_mfma_f32_16x16x32_bf16 v[104:107], v[56:59], v[72:75], v[104:107]
    s_waitcnt lgkmcnt(3)
    v_mfma_f32_16x16x32_bf16 v[104:107], v[60:63], v[76:79], v[104:107]
    s_waitcnt lgkmcnt(2)
    v_mfma_f32_16x16x32_bf16 v[108:111], v[56:59], v[80:83], v[108:111]
    s_waitcnt lgkmcnt(1)
    v_mfma_f32_16x16x32_bf16 v[108:111], v[60:63], v[84:87], v[108:111]
K2_WAITE:
    ds_read_b32 v125, v124 offset:0
    s_waitcnt lgkmcnt(0)
    v_readfirstlane_b32 s28, v125
    s_cmp_lt_u32 s28, s29
    s_setprio 0
    s_cbranch_scc1 K2_WAITE
    s_setprio 3
    s_and_b32 s28, s20, 64
    s_lshr_b32 s28, s28, 6
    s_sub_u32 s28, s25, s28
    s_mov_b64 exec, 1
    s_setprio 0
K2_WAITG:
    ds_read_b32 v125, v124 offset:16
    s_waitcnt lgkmcnt(0)
    v_cmp_gt_i32 vcc, s28, v125
    s_cbranch_vccnz K2_WAITG
    s_mov_b64 exec, -1
    s_mov_b32 s28, 0xbfb8aa3b
K2_WAITH:
    ds_read_b32 v125, v124 offset:16
    ds_read_b128 v[64:67], v4 offset:1280
    ds_read_b128 v[68:71], v5 offset:1280
    ds_read_b128 v[72:75], v6 offset:1792
    ds_read_b128 v[76:79], v7 offset:1792
    s_waitcnt lgkmcnt(4)
    v_cmp_gt_u32 vcc, s25, v125
    s_cbranch_vccnz K2_WAITH
    s_setprio 3
    ds_read_b128 v[80:83], v6 offset:1280
    ds_read_b128 v[84:87], v7 offset:1280
    ds_read_b128 v[88:91], v4 offset:1792
    ds_read_b128 v[92:95], v5 offset:1792
    ds_read_b128 v[16:19], v4 offset:256
    ds_read_b128 v[20:23], v5 offset:256
    s_waitcnt lgkmcnt(9)
    v_mfma_f32_16x16x32_bf16 v[96:99], v[32:35], v[64:67], v[96:99]
    ds_read_b128 v[64:67], v6 offset:768
    s_waitcnt lgkmcnt(9)
    v_mfma_f32_16x16x32_bf16 v[96:99], v[36:39], v[68:71], v[96:99]
    ds_read_b128 v[68:71], v7 offset:768
    s_waitcnt lgkmcnt(9)
    v_mfma_f32_16x16x32_bf16 v[96:99], v[32:35], v[72:75], v[96:99]
    ds_read_b128 v[72:75], v6 offset:256
    s_waitcnt lgkmcnt(9)
    v_mfma_f32_16x16x32_bf16 v[96:99], v[36:39], v[76:79], v[96:99]
    ds_read_b128 v[76:79], v7 offset:256
    s_waitcnt lgkmcnt(9)
    v_mfma_f32_16x16x32_bf16 v[100:103], v[56:59], v[80:83], v[100:103]
    ds_read_b128 v[80:83], v4 offset:768
    s_waitcnt lgkmcnt(9)
    v_mfma_f32_16x16x32_bf16 v[100:103], v[60:63], v[84:87], v[100:103]
    ds_read_b128 v[84:87], v5 offset:768
    s_waitcnt lgkmcnt(9)
    v_mfma_f32_16x16x32_bf16 v[100:103], v[56:59], v[88:91], v[100:103]
    v_mul_f32 v120, s28, v96
    v_mul_f32 v121, s28, v97
    v_mul_f32 v122, s28, v98
    s_waitcnt lgkmcnt(8)
    v_mfma_f32_16x16x32_bf16 v[100:103], v[60:63], v[92:95], v[100:103]
    v_mul_f32 v123, s28, v99
    v_exp_f32 v120, v120
    v_exp_f32 v121, v121
    s_waitcnt lgkmcnt(7)
    v_mfma_f32_16x16x32_bf16 v[104:107], v[48:51], v[16:19], v[104:107]
    v_exp_f32 v122, v122
    v_exp_f32 v123, v123
    s_waitcnt lgkmcnt(6)
    v_mfma_f32_16x16x32_bf16 v[104:107], v[52:55], v[20:23], v[104:107]
    v_cvt_pk_bf16_f32 v112, v96, v97
    v_cvt_pk_bf16_f32 v113, v98, v99
    v_add_f32 v120, 1.0, v120
    s_waitcnt lgkmcnt(5)
    v_mfma_f32_16x16x32_bf16 v[104:107], v[56:59], v[64:67], v[104:107]
    ds_write_b64 v11, v[112:113] offset:0
    v_add_f32 v121, 1.0, v121
    v_add_f32 v122, 1.0, v122
    v_add_f32 v123, 1.0, v123
    s_waitcnt lgkmcnt(5)
    v_mfma_f32_16x16x32_bf16 v[104:107], v[60:63], v[68:71], v[104:107]
    v_rcp_f32 v120, v120
    v_rcp_f32 v121, v121
    s_waitcnt lgkmcnt(4)
    v_mfma_f32_16x16x32_bf16 v[108:111], v[48:51], v[72:75], v[108:111]
    v_rcp_f32 v122, v122
    v_rcp_f32 v123, v123
    s_waitcnt lgkmcnt(3)
    v_mfma_f32_16x16x32_bf16 v[108:111], v[52:55], v[76:79], v[108:111]
    v_mul_f32 v100, v100, v120
    v_mul_f32 v101, v101, v121
    v_mul_f32 v102, v102, v122
    s_waitcnt lgkmcnt(2)
    v_mfma_f32_16x16x32_bf16 v[108:111], v[56:59], v[80:83], v[108:111]
    v_mul_f32 v103, v103, v123
    v_cvt_pk_bf16_f32 v114, v100, v101
    v_cvt_pk_bf16_f32 v115, v102, v103
    s_waitcnt lgkmcnt(1)
    v_mfma_f32_16x16x32_bf16 v[108:111], v[60:63], v[84:87], v[108:111]
    ds_write_b64 v11, v[114:115] offset:512
K2_FIN:
    v_mul_f32 v104, v104, v120
    v_mul_f32 v105, v105, v121
    v_mul_f32 v106, v106, v122
    v_mul_f32 v107, v107, v123
    v_cvt_pk_bf16_f32 v116, v104, v105
    v_cvt_pk_bf16_f32 v117, v106, v107
    ds_write_b64 v11, v[116:117] offset:1024
    v_mul_f32 v108, v108, v120
    v_mul_f32 v109, v109, v121
    v_mul_f32 v110, v110, v122
    v_mul_f32 v111, v111, v123
    v_cvt_pk_bf16_f32 v118, v108, v109
    v_cvt_pk_bf16_f32 v119, v110, v111
    ds_write_b64 v11, v[118:119] offset:1536
    s_mov_b64 exec, 1
    ds_add_u32 v124, v2 offset:16
    s_mov_b64 exec, -1
    s_setprio 0
K2_WAITX:
    ds_read_b32 v125, v124 offset:16
    ds_read_b128 v[64:67], v12
    ds_read_b128 v[68:71], v12 offset:4128
    s_waitcnt lgkmcnt(2)
    v_cmp_gt_u32 vcc, s29, v125
    s_cbranch_vccnz K2_WAITX
    s_setprio 3
    s_mov_b64 exec, s[34:35]
    s_cbranch_execz K2_NEXT
    s_waitcnt lgkmcnt(1)
    global_store_dwordx4 v13, v[64:67], s[4:5] sc0 sc1
    s_mov_b64 exec, s[36:37]
    s_cbranch_execz K2_NEXT
    s_waitcnt lgkmcnt(0)
    global_store_dwordx4 v13, v[68:71], s[4:5] offset:1024 sc0 sc1
K2_NEXT:
    s_mov_b64 exec, -1
    s_lshr_b32 s20, s20, 4
    s_bitcmp0_b32 s20, 2
    s_waitcnt lgkmcnt(0)
    s_cbranch_scc1 K2_TASK
K2_OUT:
K2_END:
    s_endpgm
K2_G3:
    v_mbcnt_lo_u32_b32 v4, -1, 0
    s_mov_b32 s62, 0xeb14fa50
    s_mov_b32 s63, 0x693c7d28
    v_mbcnt_hi_u32_b32 v4, -1, v4
    v_lshlrev_b32 v5, 2, v1
    v_lshrrev_b64 v[6:7], v5, s[62:63]
    v_lshrrev_b32 v4, 4, v4
    v_and_b32 v6, 15, v6
    v_lshl_add_u32 v6, v6, 3, v4
    s_mov_b32 s29, 98304
    v_lshl_add_u32 v6, v6, 4, s29
    s_add_u32 s28, s14, 48
    s_lshl4_add_u32 s28, s28, s19
    s_lshl_b32 s28, s28, 5
    v_lshl_add_u32 v7, v1, 5, s28
    v_lshl_add_u32 v7, v4, 3, v7
    v_lshl_add_u32 v124, v1, 4, v124
    s_mov_b32 s29, 0xbfb8aa3b
    s_mov_b64 exec, 3
    s_setprio 0
K2_G3W:
    ds_read_b32 v125, v124
    s_waitcnt lgkmcnt(0)
    v_cmp_eq_u32 vcc, 0, v125
    s_cbranch_vccnz K2_G3W
    s_setprio 3
    s_mov_b64 exec, -1
    ds_read_b128 v[64:67], v6
    ds_read_b128 v[68:71], v6 offset:64
    s_waitcnt lgkmcnt(1)
    v_mfma_f32_16x16x32_bf16 v[96:99], v[24:27], v[64:67], 0
    v_mfma_f32_16x16x32_bf16 v[100:103], v[32:35], v[64:67], 0
    v_mfma_f32_16x16x32_bf16 v[104:107], v[40:43], v[64:67], 0
    v_mfma_f32_16x16x32_bf16 v[108:111], v[48:51], v[64:67], 0
    v_mfma_f32_16x16x32_bf16 v[112:115], v[56:59], v[64:67], 0
    s_waitcnt lgkmcnt(0)
    v_mfma_f32_16x16x32_bf16 v[96:99], v[28:31], v[68:71], v[96:99]
    v_mfma_f32_16x16x32_bf16 v[100:103], v[36:39], v[68:71], v[100:103]
    v_mfma_f32_16x16x32_bf16 v[104:107], v[44:47], v[68:71], v[104:107]
    v_mfma_f32_16x16x32_bf16 v[108:111], v[52:55], v[68:71], v[108:111]
    v_mfma_f32_16x16x32_bf16 v[112:115], v[60:63], v[68:71], v[112:115]
    s_nop 4
    v_add_f32_dpp v96, v100, v96 quad_perm:[1,1,1,1] row_mask:0xf bank_mask:0xf
    v_add_f32_dpp v97, v101, v97 quad_perm:[1,1,1,1] row_mask:0xf bank_mask:0xf
    v_add_f32_dpp v98, v102, v98 quad_perm:[1,1,1,1] row_mask:0xf bank_mask:0xf
    v_add_f32_dpp v99, v103, v99 quad_perm:[1,1,1,1] row_mask:0xf bank_mask:0xf
    v_add_f32_dpp v96, v100, v96 quad_perm:[2,2,2,2] row_mask:0xf bank_mask:0xf
    v_add_f32_dpp v97, v101, v97 quad_perm:[2,2,2,2] row_mask:0xf bank_mask:0xf
    v_add_f32_dpp v98, v102, v98 quad_perm:[2,2,2,2] row_mask:0xf bank_mask:0xf
    v_add_f32_dpp v99, v103, v99 quad_perm:[2,2,2,2] row_mask:0xf bank_mask:0xf
    v_add_f32_dpp v96, v100, v96 quad_perm:[3,3,3,3] row_mask:0xf bank_mask:0xf
    v_add_f32_dpp v97, v101, v97 quad_perm:[3,3,3,3] row_mask:0xf bank_mask:0xf
    v_add_f32_dpp v98, v102, v98 quad_perm:[3,3,3,3] row_mask:0xf bank_mask:0xf
    v_add_f32_dpp v99, v103, v99 quad_perm:[3,3,3,3] row_mask:0xf bank_mask:0xf
    v_add_f32_dpp v104, v108, v104 quad_perm:[1,1,1,1] row_mask:0xf bank_mask:0xf
    v_add_f32_dpp v105, v109, v105 quad_perm:[1,1,1,1] row_mask:0xf bank_mask:0xf
    v_add_f32_dpp v106, v110, v106 quad_perm:[1,1,1,1] row_mask:0xf bank_mask:0xf
    v_add_f32_dpp v107, v111, v107 quad_perm:[1,1,1,1] row_mask:0xf bank_mask:0xf
    v_add_f32_dpp v104, v112, v104 quad_perm:[2,2,2,2] row_mask:0xf bank_mask:0xf
    v_add_f32_dpp v105, v113, v105 quad_perm:[2,2,2,2] row_mask:0xf bank_mask:0xf
    v_add_f32_dpp v106, v114, v106 quad_perm:[2,2,2,2] row_mask:0xf bank_mask:0xf
    v_add_f32_dpp v107, v115, v107 quad_perm:[2,2,2,2] row_mask:0xf bank_mask:0xf
    v_add_f32_dpp v104, v112, v104 quad_perm:[3,3,3,3] row_mask:0xf bank_mask:0xf
    v_add_f32_dpp v105, v113, v105 quad_perm:[3,3,3,3] row_mask:0xf bank_mask:0xf
    v_add_f32_dpp v106, v114, v106 quad_perm:[3,3,3,3] row_mask:0xf bank_mask:0xf
    v_add_f32_dpp v107, v115, v107 quad_perm:[3,3,3,3] row_mask:0xf bank_mask:0xf
    v_mul_f32 v120, s29, v96
    v_mul_f32 v121, s29, v97
    v_mul_f32 v122, s29, v98
    v_mul_f32 v123, s29, v99
    v_exp_f32 v120, v120
    v_exp_f32 v121, v121
    v_exp_f32 v122, v122
    v_exp_f32 v123, v123
    v_add_f32 v120, 1.0, v120
    v_add_f32 v121, 1.0, v121
    v_add_f32 v122, 1.0, v122
    v_add_f32 v123, 1.0, v123
    v_rcp_f32 v120, v120
    v_rcp_f32 v121, v121
    v_rcp_f32 v122, v122
    v_rcp_f32 v123, v123
    v_cvt_pk_bf16_f32 v64, v96, v97
    v_cvt_pk_bf16_f32 v65, v98, v99
    v_mul_f32_dpp v104, v120, v104 row_newbcast:0 row_mask:0xf bank_mask:0xf
    v_mul_f32_dpp v105, v121, v105 row_newbcast:0 row_mask:0xf bank_mask:0xf
    v_mul_f32_dpp v106, v122, v106 row_newbcast:0 row_mask:0xf bank_mask:0xf
    v_mul_f32_dpp v107, v123, v107 row_newbcast:0 row_mask:0xf bank_mask:0xf
    v_cvt_pk_bf16_f32 v66, v104, v105
    v_cvt_pk_bf16_f32 v67, v106, v107
    s_nop 0
    v_mov_b32_dpp v66, v64 quad_perm:[0,1,2,3] row_mask:0xf bank_mask:0x1
    v_mov_b32_dpp v67, v65 quad_perm:[0,1,2,3] row_mask:0xf bank_mask:0x1
    s_mov_b32 exec_lo, 0x11111111
    s_mov_b32 exec_hi, 0x11111111
    global_store_dwordx2 v7, v[66:67], s[4:5] sc0 sc1
    s_branch K2_NEXT
K2_FLIP:
    ds_read_b128 v[64:67], v4 offset:1280
    ds_read_b128 v[68:71], v5 offset:1280
    ds_read_b128 v[72:75], v6 offset:1280
    ds_read_b128 v[76:79], v7 offset:1280
    ds_read_b128 v[80:83], v4 offset:256
    ds_read_b128 v[84:87], v5 offset:256
    ds_read_b128 v[88:91], v6 offset:256
    ds_read_b128 v[92:95], v7 offset:256
    ds_read_b128 v[16:19], v6 offset:1792
    ds_read_b128 v[20:23], v7 offset:1792
    s_waitcnt lgkmcnt(9)
    v_mfma_f32_16x16x32_bf16 v[96:99], v[32:35], v[64:67], 0
    ds_read_b128 v[64:67], v4 offset:1792
    s_waitcnt lgkmcnt(9)
    v_mfma_f32_16x16x32_bf16 v[96:99], v[36:39], v[68:71], v[96:99]
    ds_read_b128 v[68:71], v5 offset:1792
    s_waitcnt lgkmcnt(9)
    v_mfma_f32_16x16x32_bf16 v[100:103], v[56:59], v[72:75], 0
    ds_read_b128 v[72:75], v6 offset:768
    s_waitcnt lgkmcnt(9)
    v_mfma_f32_16x16x32_bf16 v[100:103], v[60:63], v[76:79], v[100:103]
    ds_read_b128 v[76:79], v7 offset:768
    s_waitcnt lgkmcnt(9)
    v_mfma_f32_16x16x32_bf16 v[104:107], v[48:51], v[80:83], 0
    ds_read_b128 v[80:83], v4 offset:768
    s_waitcnt lgkmcnt(9)
    v_mfma_f32_16x16x32_bf16 v[104:107], v[52:55], v[84:87], v[104:107]
    ds_read_b128 v[84:87], v5 offset:768
    s_mov_b64 exec, 1
    ds_add_u32 v124, v2 offset:0
    s_mov_b64 exec, -1
    s_waitcnt lgkmcnt(10)
    v_mfma_f32_16x16x32_bf16 v[108:111], v[48:51], v[88:91], 0
    s_waitcnt lgkmcnt(9)
    v_mfma_f32_16x16x32_bf16 v[108:111], v[52:55], v[92:95], v[108:111]
    s_waitcnt lgkmcnt(8)
    v_mfma_f32_16x16x32_bf16 v[96:99], v[32:35], v[16:19], v[96:99]
    s_waitcnt lgkmcnt(7)
    v_mfma_f32_16x16x32_bf16 v[96:99], v[36:39], v[20:23], v[96:99]
    s_waitcnt lgkmcnt(6)
    v_mfma_f32_16x16x32_bf16 v[100:103], v[56:59], v[64:67], v[100:103]
    s_waitcnt lgkmcnt(5)
    v_mfma_f32_16x16x32_bf16 v[100:103], v[60:63], v[68:71], v[100:103]
    s_waitcnt lgkmcnt(4)
    v_mfma_f32_16x16x32_bf16 v[104:107], v[56:59], v[72:75], v[104:107]
    s_waitcnt lgkmcnt(3)
    v_mfma_f32_16x16x32_bf16 v[104:107], v[60:63], v[76:79], v[104:107]
    s_waitcnt lgkmcnt(2)
    v_mfma_f32_16x16x32_bf16 v[108:111], v[56:59], v[80:83], v[108:111]
    s_waitcnt lgkmcnt(1)
    v_mfma_f32_16x16x32_bf16 v[108:111], v[60:63], v[84:87], v[108:111]
K2_WAITEF:
    ds_read_b32 v125, v124 offset:0
    s_waitcnt lgkmcnt(0)
    v_readfirstlane_b32 s28, v125
    s_cmp_lt_u32 s28, s29
    s_setprio 0
    s_cbranch_scc1 K2_WAITEF
    s_setprio 3
    s_and_b32 s28, s20, 64
    s_lshr_b32 s28, s28, 6
    s_sub_u32 s28, s25, s28
    s_mov_b64 exec, 1
    s_setprio 0
K2_WAITGF:
    ds_read_b32 v125, v124 offset:16
    s_waitcnt lgkmcnt(0)
    v_cmp_gt_i32 vcc, s28, v125
    s_cbranch_vccnz K2_WAITGF
    s_mov_b64 exec, -1
    s_mov_b32 s28, 0xbfb8aa3b
K2_WAITHF:
    ds_read_b32 v125, v124 offset:16
    ds_read_b128 v[64:67], v4 offset:0
    ds_read_b128 v[68:71], v5 offset:0
    ds_read_b128 v[72:75], v6 offset:512
    ds_read_b128 v[76:79], v7 offset:512
    s_waitcnt lgkmcnt(4)
    v_cmp_gt_u32 vcc, s25, v125
    s_cbranch_vccnz K2_WAITHF
    s_setprio 3
    ds_read_b128 v[80:83], v4 offset:512
    ds_read_b128 v[84:87], v5 offset:512
    ds_read_b128 v[88:91], v6 offset:0
    ds_read_b128 v[92:95], v7 offset:0
    ds_read_b128 v[16:19], v4 offset:1024
    ds_read_b128 v[20:23], v5 offset:1024
    s_waitcnt lgkmcnt(9)
    v_mfma_f32_16x16x32_bf16 v[96:99], v[24:27], v[64:67], v[96:99]
    ds_read_b128 v[64:67], v6 offset:1536
    s_waitcnt lgkmcnt(9)
    v_mfma_f32_16x16x32_bf16 v[96:99], v[28:31], v[68:71], v[96:99]
    ds_read_b128 v[68:71], v7 offset:1536
    s_waitcnt lgkmcnt(9)
    v_mfma_f32_16x16x32_bf16 v[96:99], v[32:35], v[72:75], v[96:99]
    ds_read_b128 v[72:75], v4 offset:1536
    s_waitcnt lgkmcnt(9)
    v_mfma_f32_16x16x32_bf16 v[96:99], v[36:39], v[76:79], v[96:99]
    ds_read_b128 v[76:79], v5 offset:1536
    s_waitcnt lgkmcnt(9)
    v_mfma_f32_16x16x32_bf16 v[100:103], v[40:43], v[80:83], v[100:103]
    ds_read_b128 v[80:83], v6 offset:1024
    s_waitcnt lgkmcnt(9)
    v_mfma_f32_16x16x32_bf16 v[100:103], v[44:47], v[84:87], v[100:103]
    ds_read_b128 v[84:87], v7 offset:1024
    s_waitcnt lgkmcnt(9)
    v_mfma_f32_16x16x32_bf16 v[100:103], v[48:51], v[88:91], v[100:103]
    v_mul_f32 v120, s28, v96
    v_mul_f32 v121, s28, v97
    v_mul_f32 v122, s28, v98
    s_waitcnt lgkmcnt(8)
    v_mfma_f32_16x16x32_bf16 v[100:103], v[52:55], v[92:95], v[100:103]
    v_mul_f32 v123, s28, v99
    v_exp_f32 v120, v120
    v_exp_f32 v121, v121
    s_waitcnt lgkmcnt(7)
    v_mfma_f32_16x16x32_bf16 v[104:107], v[40:43], v[16:19], v[104:107]
    v_exp_f32 v122, v122
    v_exp_f32 v123, v123
    s_waitcnt lgkmcnt(6)
    v_mfma_f32_16x16x32_bf16 v[104:107], v[44:47], v[20:23], v[104:107]
    v_cvt_pk_bf16_f32 v112, v96, v97
    v_cvt_pk_bf16_f32 v113, v98, v99
    v_add_f32 v120, 1.0, v120
    s_waitcnt lgkmcnt(5)
    v_mfma_f32_16x16x32_bf16 v[104:107], v[56:59], v[64:67], v[104:107]
    ds_write_b64 v11, v[112:113] offset:0
    v_add_f32 v121, 1.0, v121
    v_add_f32 v122, 1.0, v122
    v_add_f32 v123, 1.0, v123
    s_waitcnt lgkmcnt(5)
    v_mfma_f32_16x16x32_bf16 v[104:107], v[60:63], v[68:71], v[104:107]
    v_rcp_f32 v120, v120
    v_rcp_f32 v121, v121
    s_waitcnt lgkmcnt(4)
    v_mfma_f32_16x16x32_bf16 v[108:111], v[40:43], v[72:75], v[108:111]
    v_rcp_f32 v122, v122
    v_rcp_f32 v123, v123
    s_waitcnt lgkmcnt(3)
    v_mfma_f32_16x16x32_bf16 v[108:111], v[44:47], v[76:79], v[108:111]
    v_mul_f32 v100, v100, v120
    v_mul_f32 v101, v101, v121
    v_mul_f32 v102, v102, v122
    s_waitcnt lgkmcnt(2)
    v_mfma_f32_16x16x32_bf16 v[108:111], v[56:59], v[80:83], v[108:111]
    v_mul_f32 v103, v103, v123
    v_cvt_pk_bf16_f32 v114, v100, v101
    v_cvt_pk_bf16_f32 v115, v102, v103
    s_waitcnt lgkmcnt(1)
    v_mfma_f32_16x16x32_bf16 v[108:111], v[60:63], v[84:87], v[108:111]
    ds_write_b64 v11, v[114:115] offset:512
    s_branch K2_FIN
.p2align 12
K_HELP:
    s_sub_u32 s61, s2, 250
    s_cbranch_scc1 K_NOCLR
    s_lshl_b32 s28, s61, 5
    v_mov_b32 v1, s28
    v_mov_b32 v2, 1
    s_cmp_eq_u32 s16, 0
    s_waitcnt vmcnt(0)
    s_barrier
    s_cbranch_scc0 K_NOCLR
    s_mov_b64 exec, 1
    global_store_dword v1, v2, s[6:7] offset:64 sc1
    s_mov_b64 exec, -1
K_NOCLR:
    v_mov_b64 v[120:121], 0
    v_mov_b64 v[122:123], 0
    v_and_b32 v126, 63, v0
    v_lshlrev_b32 v117, 4, v126
    s_movk_i32 s25, 255
    s_waitcnt lgkmcnt(0)
    s_and_b32 s57, s2, 7
    s_lshl_b32 s57, s57, 5
    s_lshr_b32 s28, s2, 3
    s_add_u32 s57, s57, s28
    s_mul_i32 s14, s57, 49
    s_sub_u32 s15, 12500, s14
    s_min_u32 s15, s15, 49
    s_lshl_b32 s30, s15, 1
    s_sub_u32 s54, s15, 1
    s_mov_b32 s10, 6400000
    s_mov_b32 s11, 0x00020000
    s_mov_b32 s26, 0x05040100
    s_mov_b32 s27, 0x07060302
    s_lshr_b32 s16, s16, 6
    s_lshl_b32 s17, s16, 8
    s_lshl2_add_u32 s3, s57, 13934592
    s_mov_b32 s50, 0
    s_add_u32 s42, s12, 13107200
    s_addc_u32 s43, s13, 0
    s_lshl_b32 s55, s16, 10
    s_add_u32 s55, s55, 51200
    s_mov_b32 s28, 106496
    v_lshl_add_u32 v110, v126, 2, s28
    v_add_u32 v1, s55, v117
    ds_write_b128 v1, v[120:123]
    ds_write_b32 v110, v120
    ds_write_b32 v110, v120 offset:96
    s_cmp_eq_u32 s16, 13
    s_cbranch_scc0 K_NOWPF
    s_lshr_b32 s28, s2, 3
    s_mul_i32 s29, s28, 6
    v_min_u32 v2, 5, v126
    v_add_lshl_u32 v2, v2, s29, 7
    global_load_dword v5, v2, s[48:49]
    s_lshl_b32 s29, s28, 2
    v_min_u32 v2, 3, v126
    v_add_lshl_u32 v2, v2, s29, 7
    global_load_dword v5, v2, s[46:47]
    s_min_u32 s28, s28, 19
    s_lshl_b32 s28, s28, 7
    v_mov_b32 v2, s28
    global_load_dword v5, v2, s[44:45]
K_NOWPF:
    s_cmp_eq_u32 s16, 15
    s_waitcnt lgkmcnt(0)
    s_barrier
    s_cbranch_scc1 K_POLL
    s_cmp_lt_u32 s16, 13
    s_cbranch_scc0 K_WDMA
    s_barrier
    s_branch K_WALK
K_WDMA:
    s_and_b32 s28, s16, 1
    s_lshl_b32 s28, s28, 10
    v_bfe_u32 v2, v126, 4, 1
    s_lshr_b32 s29, s28, 8
    v_lshl_or_b32 v2, v2, 1, s29
    v_xor_b32 v2, v2, v126
    v_lshl_add_u32 v2, v2, 4, s28
    v_lshl_add_u32 v3, v126, 4, s28
    s_add_u32 m0, s28, 40960
    v_min_u32 v4, 496, v3
    global_load_lds_dwordx4 v3, s[44:45]
    global_load_lds_dwordx4 v4, s[44:45] offset:2048
    s_mov_b32 m0, s28
    s_nop 0
    global_load_lds_dwordx4 v2, s[46:47]
    global_load_lds_dwordx4 v2, s[46:47] offset:2048
    s_add_u32 m0, s28, 16384
    s_nop 0
    global_load_lds_dwordx4 v2, s[48:49]
    global_load_lds_dwordx4 v2, s[48:49] offset:2048
    v_add_u32 v2, 4096, v2
    s_add_u32 m0, s28, 4096
    s_nop 0
    global_load_lds_dwordx4 v2, s[46:47]
    global_load_lds_dwordx4 v2, s[46:47] offset:2048
    s_add_u32 m0, s28, 20480
    s_nop 0
    global_load_lds_dwordx4 v2, s[48:49]
    global_load_lds_dwordx4 v2, s[48:49] offset:2048
    v_add_u32 v2, 4096, v2
    s_add_u32 m0, s28, 8192
    s_nop 0
    global_load_lds_dwordx4 v2, s[46:47]
    global_load_lds_dwordx4 v2, s[46:47] offset:2048
    s_add_u32 m0, s28, 24576
    s_nop 0
    global_load_lds_dwordx4 v2, s[48:49]
    global_load_lds_dwordx4 v2, s[48:49] offset:2048
    v_add_u32 v2, 4096, v2
    s_add_u32 m0, s28, 12288
    s_nop 0
    global_load_lds_dwordx4 v2, s[46:47]
    global_load_lds_dwordx4 v2, s[46:47] offset:2048
    s_add_u32 m0, s28, 28672
    s_nop 0
    global_load_lds_dwordx4 v2, s[48:49]
    global_load_lds_dwordx4 v2, s[48:49] offset:2048
    v_add_u32 v2, 4096, v2
    s_add_u32 m0, s28, 32768
    s_nop 0
    global_load_lds_dwordx4 v2, s[48:49]
    global_load_lds_dwordx4 v2, s[48:49] offset:2048
    v_add_u32 v2, 4096, v2
    s_add_u32 m0, s28, 36864
    s_nop 0
    global_load_lds_dwordx4 v2, s[48:49]
    global_load_lds_dwordx4 v2, s[48:49] offset:2048
    s_cmp_eq_u32 s16, 13
    s_waitcnt vmcnt(0)
    s_barrier
    s_cselect_b32 s53, 0x80000000, 0
    s_cselect_b32 s28, 384, 0
    s_movk_i32 s29, 256
    s_cmovk_i32 s29, 128
    v_lshl_add_u32 v8, v126, 1, s28
    v_add_u32 v9, s29, v8
    ds_read_u16 v68, v8 offset:40960
    ds_read_u16 v69, v8 offset:41600
    ds_read_u16 v70, v8 offset:42240
    ds_read_u16 v71, v8 offset:42880
    ds_read_u16 v72, v8 offset:41088
    ds_read_u16 v73, v8 offset:41728
    ds_read_u16 v74, v8 offset:42368
    ds_read_u16 v75, v8 offset:43008
    ds_read_u16 v76, v9 offset:40960
    ds_read_u16 v77, v9 offset:41600
    ds_read_u16 v78, v9 offset:42240
    ds_read_u16 v79, v9 offset:42880
    s_add_u32 s28, s28, 100352
    v_and_b32 v8, 7, v126
    v_mul_u32_u24 v8, 768, v8
    v_lshrrev_b32 v9, 3, v126
    v_lshlrev_b32 v9, 4, v9
    v_add3_u32 v8, v8, v9, s28
    s_waitcnt lgkmcnt(0)
    v_lshlrev_b32 v68, 16, v68
    v_lshlrev_b32 v69, 16, v69
    v_lshlrev_b32 v70, 16, v70
    v_lshlrev_b32 v71, 16, v71
    ds_write_b128 v8, v[68:71] offset:0
    v_lshlrev_b32 v72, 16, v72
    v_lshlrev_b32 v73, 16, v73
    v_lshlrev_b32 v74, 16, v74
    v_lshlrev_b32 v75, 16, v75
    ds_write_b128 v8, v[72:75] offset:128
    v_lshlrev_b32 v76, 16, v76
    v_xor_b32 v76, s53, v76
    v_lshlrev_b32 v77, 16, v77
    v_xor_b32 v77, s53, v77
    v_lshlrev_b32 v78, 16, v78
    v_xor_b32 v78, s53, v78
    v_lshlrev_b32 v79, 16, v79
    v_xor_b32 v79, s53, v79
    ds_write_b128 v8, v[76:79] offset:256
K_WFR:
    v_bfe_u32 v8, v126, 3, 2
    s_and_b32 s28, s16, 3
    v_xor_b32 v8, s28, v8
    v_and_b32 v9, 3, v126
    v_lshlrev_b32 v9, 3, v9
    v_lshl_add_u32 v9, v8, 5, v9
    v_bfe_u32 v8, v126, 2, 2
    v_lshl_add_u32 v9, v8, 7, v9
    v_lshrrev_b32 v8, 4, v126
    v_lshl_add_u32 v9, v8, 10, v9
    ds_read_b64_tr_b16 v[24:25], v9 offset:0
    ds_read_b64_tr_b16 v[26:27], v9 offset:512
    ds_read_b64_tr_b16 v[28:29], v9 offset:4096
    ds_read_b64_tr_b16 v[30:31], v9 offset:4608
    ds_read_b64_tr_b16 v[32:33], v9 offset:8192
    ds_read_b64_tr_b16 v[34:35], v9 offset:8704
    ds_read_b64_tr_b16 v[36:37], v9 offset:12288
    ds_read_b64_tr_b16 v[38:39], v9 offset:12800
    ds_read_b64_tr_b16 v[40:41], v9 offset:16384
    ds_read_b64_tr_b16 v[42:43], v9 offset:16896
    ds_read_b64_tr_b16 v[44:45], v9 offset:20480
    ds_read_b64_tr_b16 v[46:47], v9 offset:20992
    ds_read_b64_tr_b16 v[48:49], v9 offset:24576
    ds_read_b64_tr_b16 v[50:51], v9 offset:25088
    ds_read_b64_tr_b16 v[52:53], v9 offset:28672
    ds_read_b64_tr_b16 v[54:55], v9 offset:29184
    ds_read_b64_tr_b16 v[56:57], v9 offset:32768
    ds_read_b64_tr_b16 v[58:59], v9 offset:33280
    ds_read_b64_tr_b16 v[60:61], v9 offset:36864
    ds_read_b64_tr_b16 v[62:63], v9 offset:37376
    s_branch K2_PREP
K_POLL:
    s_setprio 3
    v_min_u32 v6, 5, v126
    v_lshlrev_b32 v6, 5, v6
    s_mul_i32 s28, s2, 1152
    s_add_u32 s28, s28, 13934592
    v_add_u32 v7, s28, v117
    s_movk_i32 s28, 4608
    v_mov_b32 v1, s3
    v_mad_u32_u24 v1, v126, s28, v1
    v_mov_b32 v2, 4096
    s_lshl_b64 vcc, 1, 63
    v_cndmask_b32 v64, v120, v2, vcc
    s_lshl_b64 vcc, 3, 62
    v_mov_b32 v65, v64
    v_cndmask_b32 v66, v120, v2, vcc
    v_mov_b32 v67, v66
    s_mul_i32 s28, s61, 11
    s_lshl_b64 s[72:73], 3, s28
    v_mul_u32_u24 v104, 12800, v126
    v_add_u32 v105, 3200, v104
    v_add_u32 v106, 6400, v104
    v_add_u32 v107, 9600, v104
    s_lshr_b32 s28, s2, 3
    s_mul_i32 s28, s28, 390
    v_lshrrev_b32 v12, 1, v126
    v_and_b32 v13, 1, v126
    v_add_lshl_u32 v12, v12, s28, 2
    v_add_lshl_u32 v12, v12, v13, 7
    s_bitcmp0_b32 s2, 0
    s_cselect_b32 s28, 1, 0
    v_lshl_add_u32 v12, s28, 8, v12
    s_lshl_b32 s60, s2, 2
    s_lshr_b32 s60, 0x99663300, s60
    s_and_b32 s60, s60, 15
    s_lshl_b32 s60, s60, 14
    s_and_b32 s28, s2, 7
    s_mul_i32 s28, s28, 36864
    s_add_u32 s28, s28, 13935616
    v_lshrrev_b32 v14, 1, v126
    v_mul_u32_u24 v14, 1144, v14
    v_lshl_add_u32 v14, v126, 2, v14
    v_add_u32 v14, s28, v14
    v_mov_b32 v15, 0x01010101
    s_movk_i32 s28, 0x0101
    v_writelane_b32 v15, s28, 62
    v_writelane_b32 v15, 0, 63
    s_cmp_lt_u32 s2, 250
    s_cbranch_scc0 K_NOPUB
    global_load_dword v8, v6, s[6:7] offset:64 sc1
    ds_read_b128 v[80:83], v117 offset:45056
    s_waitcnt lgkmcnt(0)
    v_add_u32 v85, v80, v81
    v_add_u32 v86, v85, v82
    v_add_u32 v87, v86, v83
    v_mov_b32 v84, v87
    s_nop 1
    v_add_u32_dpp v84, v84, v84 row_shr:1 row_mask:0xf bank_mask:0xf
    s_nop 1
    v_add_u32_dpp v84, v84, v84 row_shr:2 row_mask:0xf bank_mask:0xf
    s_nop 1
    v_add_u32_dpp v84, v84, v84 row_shr:4 row_mask:0xf bank_mask:0xf
    s_nop 1
    v_add_u32_dpp v84, v84, v84 row_shr:8 row_mask:0xf bank_mask:0xf
    s_nop 1
    v_add_u32_dpp v84, v84, v84 row_bcast:15 row_mask:0xa bank_mask:0xf
    s_nop 1
    v_add_u32_dpp v84, v84, v84 row_bcast:31 row_mask:0xc bank_mask:0xf
    v_sub_u32 v84, v84, v87
    v_or_b32 v84, v2, v84
    v_add_u32 v87, v84, v86
    v_add_u32 v86, v84, v85
    v_add_u32 v85, v84, v80
    v_lshl_or_b32 v80, v80, 20, v84
    v_lshl_or_b32 v81, v81, 20, v85
    v_lshl_or_b32 v82, v82, 20, v86
    v_lshl_or_b32 v83, v83, 20, v87
K_PUB0:
    s_waitcnt vmcnt(0)
    v_cmp_ne_u32 vcc, 1, v8
    s_cbranch_vccz K_PUB1
    s_sub_u32 s25, s25, 1
    s_cbranch_scc1 K_NOPUB
    global_load_dword v8, v6, s[6:7] offset:64 sc1
    s_branch K_PUB0
K_PUB1:
    global_store_dwordx4 v7, v[80:83], s[12:13] sc1
K_NOPUB:
    s_barrier
    v_bfe_u32 v8, v126, 3, 2
    s_and_b32 s28, s16, 3
    v_xor_b32 v8, s28, v8
    v_and_b32 v9, 3, v126
    v_lshlrev_b32 v9, 3, v9
    v_lshl_add_u32 v9, v8, 5, v9
    v_bfe_u32 v8, v126, 2, 2
    v_lshl_add_u32 v9, v8, 7, v9
    v_lshrrev_b32 v8, 4, v126
    v_lshl_add_u32 v9, v8, 10, v9
    ds_read_b64_tr_b16 v[24:25], v9 offset:0
    ds_read_b64_tr_b16 v[26:27], v9 offset:512
    ds_read_b64_tr_b16 v[28:29], v9 offset:4096
    ds_read_b64_tr_b16 v[30:31], v9 offset:4608
    ds_read_b64_tr_b16 v[32:33], v9 offset:8192
    ds_read_b64_tr_b16 v[34:35], v9 offset:8704
    ds_read_b64_tr_b16 v[36:37], v9 offset:12288
    ds_read_b64_tr_b16 v[38:39], v9 offset:12800
    ds_read_b64_tr_b16 v[40:41], v9 offset:16384
    ds_read_b64_tr_b16 v[42:43], v9 offset:16896
    ds_read_b64_tr_b16 v[44:45], v9 offset:20480
    ds_read_b64_tr_b16 v[46:47], v9 offset:20992
    ds_read_b64_tr_b16 v[48:49], v9 offset:24576
    ds_read_b64_tr_b16 v[50:51], v9 offset:25088
    ds_read_b64_tr_b16 v[52:53], v9 offset:28672
    ds_read_b64_tr_b16 v[54:55], v9 offset:29184
    ds_read_b64_tr_b16 v[56:57], v9 offset:32768
    ds_read_b64_tr_b16 v[58:59], v9 offset:33280
    ds_read_b64_tr_b16 v[60:61], v9 offset:36864
    ds_read_b64_tr_b16 v[62:63], v9 offset:37376
    s_lshr_b32 s28, s2, 3
    s_mul_i32 s28, s28, 1144
    s_add_u32 s28, s28, s2
    s_add_u32 s28, s28, 13935616
    s_mov_b32 s29, 36864
    v_mov_b32 v16, s28
    v_mad_u32_u24 v16, v126, s29, v16
    v_mov_b32 v17, 1
    s_cmp_lt_i32 s25, 0
    s_cbranch_scc1 K_TIMEOUT0
    s_cmp_lt_u32 s2, 250
    s_cbranch_scc0 K_POLL0A
    s_mov_b64 exec, 0xff
    s_barrier
    global_store_byte v16, v17, s[12:13] sc1
    s_lshr_b64 exec, -1, 1
    global_load_dword v64, v1, s[12:13] offset:0 sc1
    global_load_dword v65, v1, s[12:13] offset:1152 sc1
    s_lshr_b64 exec, -1, 2
    global_load_dword v66, v1, s[12:13] offset:2304 sc1
    global_load_dword v67, v1, s[12:13] offset:3456 sc1
    s_mov_b64 exec, -1
    buffer_load_dword v20, v12, s[8:11], s60 offen
    s_sub_u32 s60, s60, 180224
    s_cselect_b32 s28, 196608, 0
    s_add_u32 s60, s60, s28
    buffer_load_dword v20, v12, s[8:11], s60 offen
    s_sub_u32 s60, s60, 163840
    s_cselect_b32 s28, 196608, 0
    s_add_u32 s60, s60, s28
    s_waitcnt vmcnt(2)
    s_branch K_POLL1
K_POLL0A:
    s_barrier
K_POLL0:
    s_mov_b64 exec, s[72:73]
    v_and_b32 v8, 4096, v64
    v_and_b32 v9, 4096, v65
    v_and_b32 v10, 4096, v66
    v_and_b32 v11, 4096, v67
    v_cmp_eq_u32 s[74:75], 0, v8
    v_cmp_eq_u32 s[76:77], 0, v9
    v_cmp_eq_u32 s[20:21], 0, v10
    v_cmp_eq_u32 s[22:23], 0, v11
    s_or_b64 vcc, s[74:75], s[76:77]
    s_or_b64 s[62:63], s[20:21], s[22:23]
    s_or_b64 vcc, vcc, s[62:63]
    s_cbranch_scc0 K_POLL1
    s_mov_b64 exec, s[74:75]
    global_load_dword v64, v1, s[12:13] offset:0 sc1
    s_mov_b64 exec, s[76:77]
    global_load_dword v65, v1, s[12:13] offset:1152 sc1
    s_mov_b64 exec, s[20:21]
    global_load_dword v66, v1, s[12:13] offset:2304 sc1
    s_mov_b64 exec, s[22:23]
    global_load_dword v67, v1, s[12:13] offset:3456 sc1
    s_sub_u32 s25, s25, 1
    s_waitcnt vmcnt(0)
    s_cbranch_scc0 K_POLL0
    s_branch K_TIMEOUT
K_POLL1:
    s_mov_b64 exec, -1
    v_and_b32 v8, 4096, v64
    v_and_b32 v9, 4096, v65
    v_and_b32 v10, 4096, v66
    v_and_b32 v11, 4096, v67
    v_cmp_eq_u32 s[74:75], 0, v8
    v_cmp_eq_u32 s[76:77], 0, v9
    v_cmp_eq_u32 s[20:21], 0, v10
    v_cmp_eq_u32 s[22:23], 0, v11
    s_or_b64 vcc, s[74:75], s[76:77]
    s_or_b64 s[62:63], s[20:21], s[22:23]
    s_or_b64 vcc, vcc, s[62:63]
    s_cbranch_scc0 K_ROW
    s_mov_b64 exec, s[74:75]
    global_load_dword v64, v1, s[12:13] offset:0 sc1
    s_mov_b64 exec, s[76:77]
    global_load_dword v65, v1, s[12:13] offset:1152 sc1
    s_mov_b64 exec, s[20:21]
    global_load_dword v66, v1, s[12:13] offset:2304 sc1
    s_mov_b64 exec, s[22:23]
    global_load_dword v67, v1, s[12:13] offset:3456 sc1
    s_sub_u32 s25, s25, 1
    s_waitcnt vmcnt(0)
    s_cbranch_scc0 K_POLL1
    s_branch K_TIMEOUT
K_ROW:
K_MARK:
    s_movk_i32 s29, 3415
    s_sub_u32 s28, s55, 15360
    v_lshrrev_b32 v100, 20, v64
    v_lshrrev_b32 v101, 20, v65
    v_lshrrev_b32 v102, 20, v66
    v_lshrrev_b32 v103, 20, v67
    v_add_u32 v101, v101, v100
    v_add_u32 v102, v102, v101
    v_add_u32 v103, v103, v102
    v_mov_b32 v108, v103
    v_and_b32 v96, 0xfff, v64
    v_and_b32 v97, 0xfff, v65
    v_add_u32_dpp v108, v108, v108 row_shr:1 row_mask:0xf bank_mask:0xf
    v_and_b32 v98, 0xfff, v66
    v_and_b32 v99, 0xfff, v67
    v_add_u32_dpp v108, v108, v108 row_shr:2 row_mask:0xf bank_mask:0xf
    v_add_u32 v96, v96, v104
    v_add_u32 v97, v97, v105
    v_add_u32_dpp v108, v108, v108 row_shr:4 row_mask:0xf bank_mask:0xf
    v_add_u32 v98, v98, v106
    v_add_u32 v99, v99, v107
    v_add_u32_dpp v108, v108, v108 row_shr:8 row_mask:0xf bank_mask:0xf
    v_add_u32 v103, s50, v103
    v_mov_b32 v8, 106752
    v_add_u32_dpp v108, v108, v108 row_bcast:15 row_mask:0xa bank_mask:0xf
    v_mov_b32 v9, 12
    s_nop 0
    v_add_u32_dpp v108, v108, v108 row_bcast:31 row_mask:0xc bank_mask:0xf
    v_sub_u32 v64, v108, v103
    v_readlane_b32 s18, v108, 63
    v_add_u32 v65, v64, v100
    v_add_u32 v66, v64, v101
    v_add_u32 v67, v64, v102
    v_sub_u32 v96, v96, v64
    v_sub_u32 v97, v97, v65
    v_sub_u32 v98, v98, v66
    v_sub_u32 v99, v99, v67
    v_med3_i32 v64, v64, 0, s29
    v_med3_i32 v65, v65, 0, s29
    v_med3_i32 v66, v66, 0, s29
    v_med3_i32 v67, v67, 0, s29
    v_lshl_add_u32 v100, v64, 2, s28
    ds_max_u32 v100, v96
    v_lshl_add_u32 v101, v65, 2, s28
    ds_max_u32 v101, v97
    v_lshl_add_u32 v102, v66, 2, s28
    ds_max_u32 v102, v98
    v_lshl_add_u32 v103, v67, 2, s28
    ds_max_u32 v103, v99
    s_mov_b32 s28, 106772
    v_lshrrev_b32 v64, 8, v64
    v_lshl_add_u32 v64, v64, 2, s28
    ds_max_u32 v64, v96
    v_lshrrev_b32 v65, 8, v65
    v_lshl_add_u32 v65, v65, 2, s28
    ds_max_u32 v65, v97
    v_lshrrev_b32 v66, 8, v66
    v_lshl_add_u32 v66, v66, 2, s28
    ds_max_u32 v66, v98
    v_lshrrev_b32 v67, 8, v67
    v_lshl_add_u32 v67, v67, 2, s28
    ds_max_u32 v67, v99
    s_lshl_b64 exec, 1, 63
    ds_write2_b32 v8, v9, v108 offset1:20
    s_mov_b64 exec, -1
    s_waitcnt lgkmcnt(0)
    s_barrier
    s_cmp_lt_u32 s55, 106848
    s_cbranch_scc0 K_READY
    s_waitcnt vmcnt(2)
    global_load_dword v18, v14, s[12:13] sc1
    buffer_load_dword v20, v12, s[8:11], s60 offen
    s_sub_u32 s60, s60, 16384
    s_cselect_b32 s28, 196608, 0
    s_add_u32 s60, s60, s28
    s_waitcnt vmcnt(1)
    v_cmp_ne_u32 vcc, v15, v18
    s_cbranch_vccz K_READY
K_FLAGS:
    global_load_dword v18, v14, s[12:13] sc1
    s_waitcnt vmcnt(0)
    v_cmp_ne_u32 vcc, v15, v18
    s_cbranch_vccnz K_FLAGS
K_READY:
    s_setprio 0
K2_NOWIN:
    s_barrier
    s_mov_b64 s[32:33], 0
    s_mov_b64 s[34:35], 0
    s_mov_b64 s[36:37], 0
    s_mov_b64 s[38:39], 0
    s_barrier
    s_branch K2_Y
K2_ROUND:
    v_mov_b64 v[120:121], 0
    v_mov_b64 v[122:123], 0
    s_lshl_b32 s55, s16, 10
    s_add_u32 s55, s55, 106848
    v_lshl_add_u32 v3, v126, 4, s55
    ds_write_b128 v3, v[120:123]
    s_mov_b32 s28, 106496
    v_lshl_add_u32 v110, v126, 2, s28
    ds_write_b32 v110, v120
    ds_write_b32 v110, v120 offset:96
    s_cmp_eq_u32 s16, 15
    s_cbranch_scc0 K2_PREP
    s_movk_i32 s28, 4608
    v_mov_b32 v4, s3
    v_mad_u32_u24 v4, v126, s28, v4
    v_mov_b64 v[64:65], 0
    v_mov_b64 v[66:67], 0
    v_mov_b64 v[14:15], 0
    v_mov_b32 v12, 0
    v_mov_b32 v18, 0
    v_mul_u32_u24 v104, 12800, v126
    v_add_u32 v105, 3200, v104
    v_add_u32 v106, 6400, v104
    v_add_u32 v107, 9600, v104
    s_lshr_b64 exec, -1, 1
    global_load_dword v64, v4, s[12:13] offset:0 sc1
    global_load_dword v65, v4, s[12:13] offset:1152 sc1
    s_lshr_b64 exec, -1, 2
    global_load_dword v66, v4, s[12:13] offset:2304 sc1
    global_load_dword v67, v4, s[12:13] offset:3456 sc1
    s_mov_b64 exec, -1
    s_waitcnt vmcnt(0) lgkmcnt(0)
    s_barrier
    s_branch K_MARK
K_TIMEOUT0:
    s_barrier
K_TIMEOUT:
    s_mov_b64 exec, -1
    v_mov_b32 v3, -1
    v_mov_b32 v4, 106832
    ds_write_b32 v4, v3
    s_setprio 0
    s_waitcnt lgkmcnt(0)
    s_barrier
K_RESCUE:
    s_add_u32 s12, s12, 16777216
    s_addc_u32 s13, s13, 0
    s_add_u32 s42, s42, 16777216
    s_addc_u32 s43, s43, 0
    s_mov_b32 s63, 0
    v_lshl_add_u32 v0, s16, 6, v126
R_LOOP:
    v_lshlrev_b32 v1, 2, v126
    v_mov_b32 v2, 1
    v_mov_b32 v4, 106752
    v_writelane_b32 v2, s63, 1
    s_waitcnt vmcnt(0) lgkmcnt(0)
    s_barrier
    s_cmp_eq_u32 s16, 0
    s_cbranch_scc0 R_NOTK
    s_mov_b64 exec, 3
    global_atomic_add v3, v1, v2, s[6:7] offset:4 sc0 sc1
    s_waitcnt vmcnt(0)
    s_mov_b64 exec, 1
    ds_write_b32 v4, v3 offset:12
    s_mov_b64 exec, -1
    s_waitcnt lgkmcnt(0)
R_NOTK:
    s_barrier
    ds_read_b32 v3, v4 offset:12
    s_mov_b32 s63, 1
    s_waitcnt lgkmcnt(0)
    v_readfirstlane_b32 s61, v3
    s_cmp_ge_u32 s61, 250
    s_cbranch_scc1 R_WAIT0
    s_cmp_ge_u32 s16, 13
    s_cbranch_scc0 R_BIN
    s_barrier
    s_barrier
    s_barrier
    s_branch R_LOOP
R_BIN:
    s_mul_i32 s28, s61, 800
    v_and_b32 v65, 31, v0
    v_add_lshl_u32 v66, s28, v0, 1
    v_sub_u32 v65, v66, v65
    v_lshlrev_b32 v66, 3, v65
    v_lshlrev_b32 v67, 4, v65
    v_mul_u32_u24 v65, 12, v65
    v_and_b32 v80, 255, v0
    v_lshlrev_b32 v80, 2, v80
    v_mov_b32 v81, 0
    ds_write_b32 v80, v81 offset:45056
    v_cmp_gt_u32 vcc, 800, v0
    s_mov_b64 s[20:21], vcc
    s_mov_b64 exec, vcc
    s_waitcnt lgkmcnt(0)
    global_load_dwordx2 v[68:69], v66, s[70:71] nt
    global_load_dwordx2 v[70:71], v66, s[70:71] offset:256 nt
    s_barrier
    global_load_dwordx2 v[72:73], v66, s[68:69] nt
    global_load_dwordx2 v[74:75], v66, s[68:69] offset:256 nt
    global_load_dwordx4 v[76:79], v67, s[66:67] nt
    global_load_dwordx4 v[88:91], v67, s[66:67] offset:512 nt
    global_load_dwordx3 v[84:86], v65, s[64:65] nt
    global_load_dwordx3 v[96:98], v65, s[64:65] offset:384 nt
    v_mov_b32 v87, 1
    s_movk_i32 s22, -49
    s_waitcnt vmcnt(6)
    v_mul_u32_u24 v100, 21400, v68
    v_mul_u32_u24 v101, 21400, v69
    v_mul_u32_u24 v102, 21400, v70
    v_mul_u32_u24 v103, 21400, v71
    v_lshrrev_b32 v100, 20, v100
    v_lshrrev_b32 v101, 20, v101
    v_lshrrev_b32 v102, 20, v102
    v_lshrrev_b32 v103, 20, v103
    v_mad_i32_i24 v68, v100, s22, v68
    v_mad_i32_i24 v69, v101, s22, v69
    v_mad_i32_i24 v70, v102, s22, v70
    v_mad_i32_i24 v71, v103, s22, v71
    v_lshlrev_b32 v100, 2, v100
    ds_add_rtn_u32 v104, v100, v87 offset:45056
    v_lshlrev_b32 v101, 2, v101
    ds_add_rtn_u32 v105, v101, v87 offset:45056
    v_lshlrev_b32 v102, 2, v102
    ds_add_rtn_u32 v106, v102, v87 offset:45056
    v_lshlrev_b32 v103, 2, v103
    ds_add_rtn_u32 v107, v103, v87 offset:45056
    s_mov_b64 exec, -1
    v_and_b32 v126, 63, v0
    v_lshlrev_b32 v64, 4, v126
    s_waitcnt lgkmcnt(0)
    s_barrier
    ds_read_b128 v[92:95], v64 offset:45056
    s_waitcnt lgkmcnt(0)
    v_add_u32 v80, v92, v93
    v_add_u32 v81, v80, v94
    v_add_u32 v82, v81, v95
    v_mov_b32 v83, v82
    s_nop 1
    v_add_u32_dpp v83, v83, v83 row_shr:1 row_mask:0xf bank_mask:0xf
    s_nop 1
    v_add_u32_dpp v83, v83, v83 row_shr:2 row_mask:0xf bank_mask:0xf
    s_nop 1
    v_add_u32_dpp v83, v83, v83 row_shr:4 row_mask:0xf bank_mask:0xf
    s_nop 1
    v_add_u32_dpp v83, v83, v83 row_shr:8 row_mask:0xf bank_mask:0xf
    s_nop 1
    v_add_u32_dpp v83, v83, v83 row_bcast:15 row_mask:0xa bank_mask:0xf
    s_nop 1
    v_add_u32_dpp v83, v83, v83 row_bcast:31 row_mask:0xc bank_mask:0xf
    v_sub_u32 v116, v83, v82
    v_add_u32 v117, v116, v92
    v_add_u32 v118, v116, v80
    v_add_u32 v119, v116, v81
    ds_write_b128 v64, v[116:119] offset:46080
    s_cmp_lt_u32 s16, 12
    s_cbranch_scc1 R_NOTAB
    s_mul_i32 s28, s61, 1152
    s_add_u32 s28, s28, 13934592
    v_lshl_add_u32 v99, v126, 4, s28
    v_lshl_or_b32 v112, v92, 20, v116
    v_lshl_or_b32 v113, v93, 20, v117
    v_lshl_or_b32 v114, v94, 20, v118
    v_lshl_or_b32 v115, v95, 20, v119
    global_store_dwordx4 v99, v[112:115], s[12:13] sc1
R_NOTAB:
    s_mov_b64 exec, s[20:21]
    s_mov_b32 s28, 106848
    s_waitcnt lgkmcnt(0)
    ds_read_b32 v100, v100 offset:46080
    ds_read_b32 v101, v101 offset:46080
    ds_read_b32 v102, v102 offset:46080
    ds_read_b32 v103, v103 offset:46080
    v_lshlrev_b32 v67, 4, v0
    s_mul_i32 s29, s61, 51200
    v_add_u32 v66, s28, v67
    v_add_u32 v108, s29, v67
    v_add_u32 v109, 12800, v108
    v_add_u32 v110, 25600, v108
    v_add_u32 v111, 38400, v108
    s_waitcnt lgkmcnt(3)
    v_add_u32 v100, v100, v104
    ds_write_b8 v100, v68 offset:47104
    s_waitcnt lgkmcnt(3)
    v_add_u32 v101, v101, v105
    ds_write_b8 v101, v69 offset:47104
    s_waitcnt lgkmcnt(3)
    v_add_u32 v102, v102, v106
    ds_write_b8 v102, v70 offset:47104
    s_waitcnt lgkmcnt(3)
    v_add_u32 v103, v103, v107
    ds_write_b8 v103, v71 offset:47104
    v_lshl_add_u32 v104, v100, 4, s28
    v_lshl_add_u32 v105, v101, 4, s28
    v_lshl_add_u32 v106, v102, 4, s28
    v_lshl_add_u32 v107, v103, 4, s28
    s_waitcnt vmcnt(0)
    v_alignbit_b32 v80, v86, v85, 16
    v_alignbit_b32 v81, v73, v86, 16
    v_perm_b32 v85, v72, v85, s26
    v_mov_b64 v[82:83], v[76:77]
    ds_write_b128 v105, v[78:81]
    ds_write_b128 v104, v[82:85]
    s_waitcnt vmcnt(0)
    v_alignbit_b32 v92, v98, v97, 16
    v_alignbit_b32 v93, v75, v98, 16
    v_perm_b32 v97, v74, v97, s26
    v_mov_b64 v[94:95], v[88:89]
    ds_write_b128 v107, v[90:93]
    ds_write_b128 v106, v[94:97]
    s_waitcnt lgkmcnt(0)
    s_barrier
    ds_read_b128 v[72:75], v66 offset:0
    ds_read_b128 v[76:79], v66 offset:12800
    ds_read_b128 v[80:83], v66 offset:25600
    ds_read_b128 v[84:87], v66 offset:38400
    s_waitcnt lgkmcnt(3)
    global_store_dwordx4 v108, v[72:75], s[12:13] sc1
    s_waitcnt lgkmcnt(2)
    global_store_dwordx4 v109, v[76:79], s[12:13] sc1
    s_waitcnt lgkmcnt(1)
    global_store_dwordx4 v110, v[80:83], s[12:13] sc1
    s_waitcnt lgkmcnt(0)
    global_store_dwordx4 v111, v[84:87], s[12:13] sc1
    s_cmp_lt_u32 s16, 4
    s_cbranch_scc0 R_NOBYT
    s_mul_i32 s29, s61, 3200
    v_add_u32 v66, s29, v67
    v_cmp_gt_u32 vcc, 200, v0
    s_mov_b64 exec, vcc
    ds_read_b128 v[88:91], v67 offset:47104
    s_waitcnt lgkmcnt(0)
    global_store_dwordx4 v66, v[88:91], s[42:43] sc1
R_NOBYT:
    s_mov_b64 exec, -1
    s_branch R_LOOP
R_WAIT0:
R_WAIT:
    v_mov_b32 v1, 8
    global_load_dword v3, v1, s[6:7] sc1
    s_waitcnt vmcnt(0)
    v_readfirstlane_b32 s28, v3
    s_cmp_lt_u32 s28, 250
    s_cbranch_scc1 R_WAIT
    s_barrier
    s_branch K2_ROUND
K2_ACC:
    ds_read_b128 v[12:15], v8
    s_waitcnt lgkmcnt(0)
    v_lshlrev_b32 v9, 16, v12
    v_and_b32 v10, 0xffff0000, v12
    v_add_f32 v16, v16, v9
    v_add_f32 v17, v17, v10
    v_lshlrev_b32 v9, 16, v13
    v_and_b32 v10, 0xffff0000, v13
    v_add_f32 v18, v18, v9
    v_add_f32 v19, v19, v10
    v_lshlrev_b32 v9, 16, v14
    v_and_b32 v10, 0xffff0000, v14
    v_add_f32 v20, v20, v9
    v_add_f32 v21, v21, v10
    v_lshlrev_b32 v9, 16, v15
    v_and_b32 v10, 0xffff0000, v15
    v_add_f32 v22, v22, v9
    v_add_f32 v23, v23, v10
    s_branch K2_NOACC
.section .rodata,"a"
.p2align 6
.amdhsa_kernel standalone__tensor_product_equiv_equiformer__graph_kernel
  .amdhsa_next_free_vgpr 128
  .amdhsa_next_free_sgpr 80
  .amdhsa_accum_offset 128
  .amdhsa_group_segment_fixed_size 0
  .amdhsa_kernarg_size 96
  .amdhsa_user_sgpr_count 2
  .amdhsa_user_sgpr_kernarg_segment_ptr 1
  .amdhsa_system_sgpr_workgroup_id_x 1
  .amdhsa_float_denorm_mode_32 3
.end_amdhsa_kernel
```
